```python
import torch

def _softmax(x, axis=-1):
    return torch.softmax(x, dim=axis)
def _gelu(x):
    return torch.nn.functional.gelu(x, approximate="tanh")
def _silu(x):
    return torch.nn.functional.silu(x)
def _sigmoid(x):
    return torch.sigmoid(x)
def _layernorm(x, axis=-1, eps=1e-5):
    m = x.mean(dim=axis, keepdim=True)
    v = x.var(dim=axis, keepdim=True, unbiased=False)
    return (x - m) / torch.sqrt(v + eps)
def _scatter_add(tgt, idx, src, axis=0):
    return tgt.clone().index_add_(axis, idx, src)
def _segment_sum(src, seg, n):
    out = torch.zeros((n,) + src.shape[1:], dtype=src.dtype)
    return out.index_add_(0, seg, src)
def _pad(x, pw):
    flat = tuple(v for pair in reversed(pw) for v in pair)
    return torch.nn.functional.pad(x, flat)

kernel_name = 'concat_heads__ssm_conv_h3__softmax_full_mha__prompt'

def setup_inputs():

    _w = (lambda a: (lambda t: t.to(torch.bfloat16) if t.is_floating_point() else t)(torch.as_tensor(a)))
    def _A_setup():
        B, S, D = 1, 2048, 1024
        ks = 4
        return {
            "q": _w((lambda *s: torch.randn(*s, dtype=torch.bfloat16) * 0.05)(B, S, D)),
            "k": _w((lambda *s: torch.randn(*s, dtype=torch.bfloat16) * 0.8)(B, S, D)),
            "v": _w((lambda *s: torch.randn(*s, dtype=torch.bfloat16) * 0.8)(B, S, D)),
            "shift_k": _w((lambda *s: torch.randn(*s, dtype=torch.bfloat16) * 0.8)(D, ks) * 0.5),
            "ssm_k": _w((lambda *s: torch.randn(*s, dtype=torch.bfloat16) * 0.8)(D, S) * (1.0 / S ** 0.5)),
            "ssm_D": _w((lambda *s: torch.randn(*s, dtype=torch.bfloat16) * 0.8)(D)),
        }
    _A_in = _A_setup()

    def _B_setup():
        B, S, D = 1, 2048, 1024
        return {
            "x": _w((lambda *s: torch.randn(*s, dtype=torch.bfloat16) * 0.2)(B, S, D)),
            "wqkv": _w((lambda *s: torch.randn(*s, dtype=torch.bfloat16) * 0.2)(D, 3 * D)),
            "wo": _w((lambda *s: torch.randn(*s, dtype=torch.bfloat16) * 0.05)(D, D)),
        }
    _B_in = _B_setup()

    return {
        "A_q": _A_in["q"],
        "A_k": _A_in["k"],
        "A_v": _A_in["v"],
        "A_shift_k": _A_in["shift_k"],
        "A_ssm_k": _A_in["ssm_k"],
        "A_ssm_D": _A_in["ssm_D"],
        "B_x": _B_in["x"],
        "B_wqkv": _B_in["wqkv"],
        "B_wo": _B_in["wo"],
    }

def reference(A_q, A_k, A_v, A_shift_k, A_ssm_k, A_ssm_D, B_x, B_wqkv, B_wo):
    def _A_ref(q, k, v, shift_k, ssm_k, ssm_D):
        B, S, D = q.shape
        ks = shift_k.shape[-1]
        k_pad = _pad(k, ((0, 0), (ks - 1, 0), (0, 0)))
        k_shift = torch.zeros_like(k)
        for t in range(ks):
            k_shift = k_shift + k_pad[:, t:t + S, :] * shift_k[:, ks - 1 - t][None, None, :]
        kv = k_shift * v
        L = 2 * S
        kv_pad = _pad(kv, ((0, 0), (0, S), (0, 0)))
        kf_pad = _pad(ssm_k, ((0, 0), (0, S)))
        kv_f = (lambda x, axes=(-2,-1): torch.fft.rfft2(x.float(), dim=axes))(kv_pad[:, None, :, :], axes=(1, 2))
        kf_f = (lambda x, axes=(-2,-1): torch.fft.rfft2(x.float(), dim=axes))(kf_pad[:, None, :], axes=(1, 2))
        kf_f = (lambda x, *d: x.permute(*d))(kf_f, 1, 2, 0)
        y_f = kv_f * kf_f[None, :, :, :]
        y = (lambda x, s, axes=(-2,-1): torch.fft.irfft2(x, s=s, dim=axes).to(torch.bfloat16))(y_f, (1, L), axes=(1, 2))[:, 0, :S, :]
        y = y + kv * ssm_D[None, None, :]
        return q * y

    def _B_ref(x, wqkv, wo):
        B, S, D = x.shape
        H = 32; Dh = D // H
        qkv = (lambda x, *d: x.permute(*d))((x @ wqkv).reshape(B, S, 3, H, Dh), 2, 0, 3, 1, 4)
        q, k, v = qkv[0], qkv[1], qkv[2]
        scale = Dh ** -0.5
        scores = torch.einsum("bhqd,bhkd->bhqk", q, k) * scale
        p = _softmax(scores, axis=-1)
        o = torch.einsum("bhqk,bhkd->bhqd", p, v)
        return (lambda x, *d: x.permute(*d))(o, 0, 2, 1, 3).reshape(B, S, D) @ wo

    a = _A_ref(A_q, A_k, A_v, A_shift_k, A_ssm_k, A_ssm_D)
    b = _B_ref(B_x, B_wqkv, B_wo)
    return torch.concatenate([a, b], axis=-1)
```

```asm
; @launch kernel=kf_kernel grid=(256,1,1) block=(768,1,1) lds=163840
.amdgcn_target "amdgcn-amd-amdhsa--gfx950"
.text
.globl kf_kernel
.p2align 8
.type kf_kernel,@function
kf_kernel:
    s_cmp_ge_u32 s2, 256
    s_cbranch_scc1 L_kfend_1
    s_load_dwordx16 s[60:75], s[0:1], 0
    s_load_dwordx8 s[76:83], s[0:1], 64
    v_lshrrev_b32 v1, 6, v0
    s_nop 0
    v_readfirstlane_b32 s28, v1
    v_and_b32 v0, 63, v0
    s_and_b32 s31, s2, 7
    s_lshr_b32 s8, s2, 3
    s_lshl_b32 s29, s31, 2
    s_lshr_b32 s9, s8, 3
    s_add_u32 s29, s29, s9
    s_and_b32 s30, s8, 7
    s_and_b32 s3, s31, 3
    s_lshl_b32 s3, s3, 2
    s_and_b32 s9, s8, 3
    s_add_u32 s3, s3, s9
    s_lshr_b32 s4, s31, 2
    s_lshl_b32 s4, s4, 3
    s_lshr_b32 s9, s8, 2
    s_add_u32 s4, s4, s9
    s_and_b32 s5, s31, 1
    s_lshl_b32 s5, s5, 3
    s_and_b32 s9, s8, 7
    s_add_u32 s5, s5, s9
    s_lshr_b32 s6, s31, 1
    s_lshl_b32 s6, s6, 2
    s_lshr_b32 s9, s8, 3
    s_add_u32 s6, s6, s9
    v_lshlrev_b32 v1, 4, v0
    s_waitcnt lgkmcnt(0)
    s_mov_b32 s12, s82
    s_and_b32 s13, s83, 0xffff
    s_mov_b32 s14, 41943040
    s_mov_b32 s15, 0x00020000
    s_mov_b32 s16, s68
    s_and_b32 s17, s69, 0xffff
    s_mov_b32 s18, 4194304
    s_mov_b32 s19, 0x00020000
    s_mov_b32 s20, s76
    s_and_b32 s21, s77, 0xffff
    s_mov_b32 s22, 2097152
    s_mov_b32 s23, 0x00020000
    s_mov_b32 s24, s60
    s_and_b32 s25, s61, 0xffff
    s_mov_b32 s26, 4194304
    s_mov_b32 s27, 0x00020000
    s_mov_b32 s32, s80
    s_and_b32 s33, s81, 0xffff
    s_mov_b32 s34, 256
    s_mov_b32 s35, 0x00020000
    s_mov_b32 s36, s78
    s_and_b32 s37, s79, 0xffff
    s_mov_b32 s38, 8388608
    s_mov_b32 s39, 0x00020000
    s_mov_b32 s40, s72
    s_and_b32 s41, s73, 0xffff
    s_mov_b32 s42, 4194304
    s_mov_b32 s43, 0x00020000
    s_mov_b32 s44, s74
    s_and_b32 s45, s75, 0xffff
    s_mov_b32 s46, 6291456
    s_mov_b32 s47, 0x00020000
    s_mov_b32 s48, s62
    s_and_b32 s49, s63, 0xffff
    s_mov_b32 s50, 4194304
    s_mov_b32 s51, 0x00020000
    s_mov_b32 s52, s64
    s_and_b32 s53, s65, 0xffff
    s_mov_b32 s54, 4194304
    s_mov_b32 s55, 0x00020000
    s_mov_b32 s56, s66
    s_and_b32 s57, s67, 0xffff
    s_mov_b32 s58, 8192
    s_mov_b32 s59, 0x00020000
    s_mov_b32 s10, s70
    s_mov_b32 s11, s71
    s_cmp_lt_u32 s28, 4
    s_cbranch_scc1 L_roleC_2
    s_cmp_lt_u32 s28, 6
    s_cbranch_scc1 L_roleD_3
    s_cmp_lt_u32 s28, 8
    s_cbranch_scc1 L_roleP_4
    s_branch L_roleH_5
L_roleD_3:
    s_sub_u32 s60, s28, 4
    v_lshrrev_b32 v4, 3, v0
    v_and_b32 v5, 7, v0
    v_lshrrev_b32 v6, 1, v4
    v_xor_b32 v7, v5, v6
    v_lshlrev_b32 v7, 4, v7
    v_lshl_add_u32 v10, v4, 11, v7
    v_xor_b32 v11, 64, v10
    v_and_b32 v6, 1, v6
    v_lshlrev_b32 v6, 2, v6
    v_xor_b32 v7, v5, v6
    v_lshlrev_b32 v7, 4, v7
    v_mul_u32_u24 v12, 6144, v4
    v_add_u32 v12, v12, v7
    s_lshl_b32 s31, s5, 18
    s_lshl_b32 s61, s60, 17
    s_add_u32 s61, s61, s31
    s_lshl_b32 s62, s6, 7
    s_lshl_b32 s70, s60, 13
    s_mul_i32 s71, s60, 12288
    s_add_u32 s71, s71, 16384
    s_mov_b32 s72, 0
    s_mov_b32 s73, 0
    s_cmp_eq_u32 s60, 1
    s_cbranch_scc1 L_d1_8
    s_lshl_b32 s75, s72, 7
    s_add_u32 s75, s75, s61
    s_mul_i32 s76, s72, 393216
    s_add_u32 s76, s76, s62
    s_add_u32 s77, s70, s73
    s_add_u32 s78, s71, s73
    s_add_u32 m0, s77, 0
    s_add_u32 s31, s75, 0
    buffer_load_dwordx4 v10, s[40:43], s31 offen lds
    s_add_u32 m0, s77, 1024
    s_add_u32 s31, s75, 16384
    buffer_load_dwordx4 v11, s[40:43], s31 offen lds
    s_add_u32 m0, s77, 2048
    s_add_u32 s31, s75, 32768
    buffer_load_dwordx4 v10, s[40:43], s31 offen lds
    s_add_u32 m0, s77, 3072
    s_add_u32 s31, s75, 49152
    buffer_load_dwordx4 v11, s[40:43], s31 offen lds
    s_add_u32 m0, s77, 4096
    s_add_u32 s31, s75, 65536
    buffer_load_dwordx4 v10, s[40:43], s31 offen lds
    s_add_u32 m0, s77, 5120
    s_add_u32 s31, s75, 81920
    buffer_load_dwordx4 v11, s[40:43], s31 offen lds
    s_add_u32 m0, s77, 6144
    s_add_u32 s31, s75, 98304
    buffer_load_dwordx4 v10, s[40:43], s31 offen lds
    s_add_u32 m0, s77, 7168
    s_add_u32 s31, s75, 114688
    buffer_load_dwordx4 v11, s[40:43], s31 offen lds
    s_add_u32 m0, s78, 0
    s_add_u32 s31, s76, 0
    buffer_load_dwordx4 v12, s[44:47], s31 offen lds
    s_add_u32 m0, s78, 1024
    s_add_u32 s31, s76, 49152
    buffer_load_dwordx4 v12, s[44:47], s31 offen lds
    s_add_u32 m0, s78, 2048
    s_add_u32 s31, s76, 98304
    buffer_load_dwordx4 v12, s[44:47], s31 offen lds
    s_add_u32 m0, s78, 3072
    s_add_u32 s31, s76, 147456
    buffer_load_dwordx4 v12, s[44:47], s31 offen lds
    s_add_u32 m0, s78, 4096
    s_add_u32 s31, s76, 196608
    buffer_load_dwordx4 v12, s[44:47], s31 offen lds
    s_add_u32 m0, s78, 5120
    s_add_u32 s31, s76, 245760
    buffer_load_dwordx4 v12, s[44:47], s31 offen lds
    s_add_u32 m0, s78, 6144
    s_add_u32 s31, s76, 294912
    buffer_load_dwordx4 v12, s[44:47], s31 offen lds
    s_add_u32 m0, s78, 7168
    s_add_u32 s31, s76, 344064
    buffer_load_dwordx4 v12, s[44:47], s31 offen lds
    s_add_u32 m0, s78, 8192
    s_add_u32 s31, s76, 2048
    buffer_load_dwordx4 v12, s[44:47], s31 offen lds
    s_add_u32 m0, s78, 9216
    s_add_u32 s31, s76, 51200
    buffer_load_dwordx4 v12, s[44:47], s31 offen lds
    s_add_u32 m0, s78, 10240
    s_add_u32 s31, s76, 100352
    buffer_load_dwordx4 v12, s[44:47], s31 offen lds
    s_add_u32 m0, s78, 11264
    s_add_u32 s31, s76, 149504
    buffer_load_dwordx4 v12, s[44:47], s31 offen lds
    s_add_u32 s72, s72, 1
    s_cmp_eq_u32 s73, 0
    s_cselect_b32 s73, 122880, s73
    s_sub_u32 s73, s73, 40960
    s_lshl_b32 s75, s72, 7
    s_add_u32 s75, s75, s61
    s_mul_i32 s76, s72, 393216
    s_add_u32 s76, s76, s62
    s_add_u32 s77, s70, s73
    s_add_u32 s78, s71, s73
    s_add_u32 m0, s77, 0
    s_add_u32 s31, s75, 0
    buffer_load_dwordx4 v10, s[40:43], s31 offen lds
    s_add_u32 m0, s77, 1024
    s_add_u32 s31, s75, 16384
    buffer_load_dwordx4 v11, s[40:43], s31 offen lds
    s_add_u32 m0, s77, 2048
    s_add_u32 s31, s75, 32768
    buffer_load_dwordx4 v10, s[40:43], s31 offen lds
    s_add_u32 m0, s77, 3072
    s_add_u32 s31, s75, 49152
    buffer_load_dwordx4 v11, s[40:43], s31 offen lds
    s_add_u32 m0, s77, 4096
    s_add_u32 s31, s75, 65536
    buffer_load_dwordx4 v10, s[40:43], s31 offen lds
    s_add_u32 m0, s77, 5120
    s_add_u32 s31, s75, 81920
    buffer_load_dwordx4 v11, s[40:43], s31 offen lds
    s_add_u32 m0, s77, 6144
    s_add_u32 s31, s75, 98304
    buffer_load_dwordx4 v10, s[40:43], s31 offen lds
    s_add_u32 m0, s77, 7168
    s_add_u32 s31, s75, 114688
    buffer_load_dwordx4 v11, s[40:43], s31 offen lds
    s_add_u32 m0, s78, 0
    s_add_u32 s31, s76, 0
    buffer_load_dwordx4 v12, s[44:47], s31 offen lds
    s_add_u32 m0, s78, 1024
    s_add_u32 s31, s76, 49152
    buffer_load_dwordx4 v12, s[44:47], s31 offen lds
    s_add_u32 m0, s78, 2048
    s_add_u32 s31, s76, 98304
    buffer_load_dwordx4 v12, s[44:47], s31 offen lds
    s_add_u32 m0, s78, 3072
    s_add_u32 s31, s76, 147456
    buffer_load_dwordx4 v12, s[44:47], s31 offen lds
    s_add_u32 m0, s78, 4096
    s_add_u32 s31, s76, 196608
    buffer_load_dwordx4 v12, s[44:47], s31 offen lds
    s_add_u32 m0, s78, 5120
    s_add_u32 s31, s76, 245760
    buffer_load_dwordx4 v12, s[44:47], s31 offen lds
    s_add_u32 m0, s78, 6144
    s_add_u32 s31, s76, 294912
    buffer_load_dwordx4 v12, s[44:47], s31 offen lds
    s_add_u32 m0, s78, 7168
    s_add_u32 s31, s76, 344064
    buffer_load_dwordx4 v12, s[44:47], s31 offen lds
    s_add_u32 m0, s78, 8192
    s_add_u32 s31, s76, 2048
    buffer_load_dwordx4 v12, s[44:47], s31 offen lds
    s_add_u32 m0, s78, 9216
    s_add_u32 s31, s76, 51200
    buffer_load_dwordx4 v12, s[44:47], s31 offen lds
    s_add_u32 m0, s78, 10240
    s_add_u32 s31, s76, 100352
    buffer_load_dwordx4 v12, s[44:47], s31 offen lds
    s_add_u32 m0, s78, 11264
    s_add_u32 s31, s76, 149504
    buffer_load_dwordx4 v12, s[44:47], s31 offen lds
    s_add_u32 s72, s72, 1
    s_cmp_eq_u32 s73, 0
    s_cselect_b32 s73, 122880, s73
    s_sub_u32 s73, s73, 40960
    s_waitcnt vmcnt(20)
    s_barrier
    s_mov_b32 s79, 0
L_dl_9:
    s_lshl_b32 s75, s72, 7
    s_add_u32 s75, s75, s61
    s_mul_i32 s76, s72, 393216
    s_add_u32 s76, s76, s62
    s_add_u32 s77, s70, s73
    s_add_u32 s78, s71, s73
    s_add_u32 m0, s77, 0
    s_add_u32 s31, s75, 0
    buffer_load_dwordx4 v10, s[40:43], s31 offen lds
    s_add_u32 m0, s77, 1024
    s_add_u32 s31, s75, 16384
    buffer_load_dwordx4 v11, s[40:43], s31 offen lds
    s_add_u32 m0, s77, 2048
    s_add_u32 s31, s75, 32768
    buffer_load_dwordx4 v10, s[40:43], s31 offen lds
    s_add_u32 m0, s77, 3072
    s_add_u32 s31, s75, 49152
    buffer_load_dwordx4 v11, s[40:43], s31 offen lds
    s_add_u32 m0, s77, 4096
    s_add_u32 s31, s75, 65536
    buffer_load_dwordx4 v10, s[40:43], s31 offen lds
    s_add_u32 m0, s77, 5120
    s_add_u32 s31, s75, 81920
    buffer_load_dwordx4 v11, s[40:43], s31 offen lds
    s_add_u32 m0, s77, 6144
    s_add_u32 s31, s75, 98304
    buffer_load_dwordx4 v10, s[40:43], s31 offen lds
    s_add_u32 m0, s77, 7168
    s_add_u32 s31, s75, 114688
    buffer_load_dwordx4 v11, s[40:43], s31 offen lds
    s_add_u32 m0, s78, 0
    s_add_u32 s31, s76, 0
    buffer_load_dwordx4 v12, s[44:47], s31 offen lds
    s_add_u32 m0, s78, 1024
    s_add_u32 s31, s76, 49152
    buffer_load_dwordx4 v12, s[44:47], s31 offen lds
    s_add_u32 m0, s78, 2048
    s_add_u32 s31, s76, 98304
    buffer_load_dwordx4 v12, s[44:47], s31 offen lds
    s_add_u32 m0, s78, 3072
    s_add_u32 s31, s76, 147456
    buffer_load_dwordx4 v12, s[44:47], s31 offen lds
    s_add_u32 m0, s78, 4096
    s_add_u32 s31, s76, 196608
    buffer_load_dwordx4 v12, s[44:47], s31 offen lds
    s_add_u32 m0, s78, 5120
    s_add_u32 s31, s76, 245760
    buffer_load_dwordx4 v12, s[44:47], s31 offen lds
    s_add_u32 m0, s78, 6144
    s_add_u32 s31, s76, 294912
    buffer_load_dwordx4 v12, s[44:47], s31 offen lds
    s_add_u32 m0, s78, 7168
    s_add_u32 s31, s76, 344064
    buffer_load_dwordx4 v12, s[44:47], s31 offen lds
    s_add_u32 m0, s78, 8192
    s_add_u32 s31, s76, 2048
    buffer_load_dwordx4 v12, s[44:47], s31 offen lds
    s_add_u32 m0, s78, 9216
    s_add_u32 s31, s76, 51200
    buffer_load_dwordx4 v12, s[44:47], s31 offen lds
    s_add_u32 m0, s78, 10240
    s_add_u32 s31, s76, 100352
    buffer_load_dwordx4 v12, s[44:47], s31 offen lds
    s_add_u32 m0, s78, 11264
    s_add_u32 s31, s76, 149504
    buffer_load_dwordx4 v12, s[44:47], s31 offen lds
    s_add_u32 s72, s72, 1
    s_cmp_eq_u32 s73, 0
    s_cselect_b32 s73, 122880, s73
    s_sub_u32 s73, s73, 40960
    s_waitcnt vmcnt(20)
    s_barrier
    s_add_u32 s79, s79, 1
    s_cmp_lt_u32 s79, 14
    s_cbranch_scc1 L_dl_9
    s_branch L_convdma_6
L_d1_8:
    s_lshl_b32 s75, s72, 7
    s_add_u32 s75, s75, s61
    s_mul_i32 s76, s72, 393216
    s_add_u32 s76, s76, s62
    s_add_u32 s77, s70, s73
    s_add_u32 s78, s71, s73
    s_add_u32 m0, s77, 0
    s_add_u32 s31, s75, 0
    buffer_load_dwordx4 v10, s[40:43], s31 offen lds
    s_add_u32 m0, s77, 1024
    s_add_u32 s31, s75, 16384
    buffer_load_dwordx4 v11, s[40:43], s31 offen lds
    s_add_u32 m0, s77, 2048
    s_add_u32 s31, s75, 32768
    buffer_load_dwordx4 v10, s[40:43], s31 offen lds
    s_add_u32 m0, s77, 3072
    s_add_u32 s31, s75, 49152
    buffer_load_dwordx4 v11, s[40:43], s31 offen lds
    s_add_u32 m0, s77, 4096
    s_add_u32 s31, s75, 65536
    buffer_load_dwordx4 v10, s[40:43], s31 offen lds
    s_add_u32 m0, s77, 5120
    s_add_u32 s31, s75, 81920
    buffer_load_dwordx4 v11, s[40:43], s31 offen lds
    s_add_u32 m0, s77, 6144
    s_add_u32 s31, s75, 98304
    buffer_load_dwordx4 v10, s[40:43], s31 offen lds
    s_add_u32 m0, s77, 7168
    s_add_u32 s31, s75, 114688
    buffer_load_dwordx4 v11, s[40:43], s31 offen lds
    s_add_u32 m0, s78, 0
    s_add_u32 s31, s76, 198656
    buffer_load_dwordx4 v12, s[44:47], s31 offen lds
    s_add_u32 m0, s78, 1024
    s_add_u32 s31, s76, 247808
    buffer_load_dwordx4 v12, s[44:47], s31 offen lds
    s_add_u32 m0, s78, 2048
    s_add_u32 s31, s76, 296960
    buffer_load_dwordx4 v12, s[44:47], s31 offen lds
    s_add_u32 m0, s78, 3072
    s_add_u32 s31, s76, 346112
    buffer_load_dwordx4 v12, s[44:47], s31 offen lds
    s_add_u32 m0, s78, 4096
    s_add_u32 s31, s76, 4096
    buffer_load_dwordx4 v12, s[44:47], s31 offen lds
    s_add_u32 m0, s78, 5120
    s_add_u32 s31, s76, 53248
    buffer_load_dwordx4 v12, s[44:47], s31 offen lds
    s_add_u32 m0, s78, 6144
    s_add_u32 s31, s76, 102400
    buffer_load_dwordx4 v12, s[44:47], s31 offen lds
    s_add_u32 m0, s78, 7168
    s_add_u32 s31, s76, 151552
    buffer_load_dwordx4 v12, s[44:47], s31 offen lds
    s_add_u32 m0, s78, 8192
    s_add_u32 s31, s76, 200704
    buffer_load_dwordx4 v12, s[44:47], s31 offen lds
    s_add_u32 m0, s78, 9216
    s_add_u32 s31, s76, 249856
    buffer_load_dwordx4 v12, s[44:47], s31 offen lds
    s_add_u32 m0, s78, 10240
    s_add_u32 s31, s76, 299008
    buffer_load_dwordx4 v12, s[44:47], s31 offen lds
    s_add_u32 m0, s78, 11264
    s_add_u32 s31, s76, 348160
    buffer_load_dwordx4 v12, s[44:47], s31 offen lds
    s_add_u32 s72, s72, 1
    s_cmp_eq_u32 s73, 0
    s_cselect_b32 s73, 122880, s73
    s_sub_u32 s73, s73, 40960
    s_lshl_b32 s75, s72, 7
    s_add_u32 s75, s75, s61
    s_mul_i32 s76, s72, 393216
    s_add_u32 s76, s76, s62
    s_add_u32 s77, s70, s73
    s_add_u32 s78, s71, s73
    s_add_u32 m0, s77, 0
    s_add_u32 s31, s75, 0
    buffer_load_dwordx4 v10, s[40:43], s31 offen lds
    s_add_u32 m0, s77, 1024
    s_add_u32 s31, s75, 16384
    buffer_load_dwordx4 v11, s[40:43], s31 offen lds
    s_add_u32 m0, s77, 2048
    s_add_u32 s31, s75, 32768
    buffer_load_dwordx4 v10, s[40:43], s31 offen lds
    s_add_u32 m0, s77, 3072
    s_add_u32 s31, s75, 49152
    buffer_load_dwordx4 v11, s[40:43], s31 offen lds
    s_add_u32 m0, s77, 4096
    s_add_u32 s31, s75, 65536
    buffer_load_dwordx4 v10, s[40:43], s31 offen lds
    s_add_u32 m0, s77, 5120
    s_add_u32 s31, s75, 81920
    buffer_load_dwordx4 v11, s[40:43], s31 offen lds
    s_add_u32 m0, s77, 6144
    s_add_u32 s31, s75, 98304
    buffer_load_dwordx4 v10, s[40:43], s31 offen lds
    s_add_u32 m0, s77, 7168
    s_add_u32 s31, s75, 114688
    buffer_load_dwordx4 v11, s[40:43], s31 offen lds
    s_add_u32 m0, s78, 0
    s_add_u32 s31, s76, 198656
    buffer_load_dwordx4 v12, s[44:47], s31 offen lds
    s_add_u32 m0, s78, 1024
    s_add_u32 s31, s76, 247808
    buffer_load_dwordx4 v12, s[44:47], s31 offen lds
    s_add_u32 m0, s78, 2048
    s_add_u32 s31, s76, 296960
    buffer_load_dwordx4 v12, s[44:47], s31 offen lds
    s_add_u32 m0, s78, 3072
    s_add_u32 s31, s76, 346112
    buffer_load_dwordx4 v12, s[44:47], s31 offen lds
    s_add_u32 m0, s78, 4096
    s_add_u32 s31, s76, 4096
    buffer_load_dwordx4 v12, s[44:47], s31 offen lds
    s_add_u32 m0, s78, 5120
    s_add_u32 s31, s76, 53248
    buffer_load_dwordx4 v12, s[44:47], s31 offen lds
    s_add_u32 m0, s78, 6144
    s_add_u32 s31, s76, 102400
    buffer_load_dwordx4 v12, s[44:47], s31 offen lds
    s_add_u32 m0, s78, 7168
    s_add_u32 s31, s76, 151552
    buffer_load_dwordx4 v12, s[44:47], s31 offen lds
    s_add_u32 m0, s78, 8192
    s_add_u32 s31, s76, 200704
    buffer_load_dwordx4 v12, s[44:47], s31 offen lds
    s_add_u32 m0, s78, 9216
    s_add_u32 s31, s76, 249856
    buffer_load_dwordx4 v12, s[44:47], s31 offen lds
    s_add_u32 m0, s78, 10240
    s_add_u32 s31, s76, 299008
    buffer_load_dwordx4 v12, s[44:47], s31 offen lds
    s_add_u32 m0, s78, 11264
    s_add_u32 s31, s76, 348160
    buffer_load_dwordx4 v12, s[44:47], s31 offen lds
    s_add_u32 s72, s72, 1
    s_cmp_eq_u32 s73, 0
    s_cselect_b32 s73, 122880, s73
    s_sub_u32 s73, s73, 40960
    s_waitcnt vmcnt(20)
    s_barrier
    s_mov_b32 s79, 0
L_dl_10:
    s_lshl_b32 s75, s72, 7
    s_add_u32 s75, s75, s61
    s_mul_i32 s76, s72, 393216
    s_add_u32 s76, s76, s62
    s_add_u32 s77, s70, s73
    s_add_u32 s78, s71, s73
    s_add_u32 m0, s77, 0
    s_add_u32 s31, s75, 0
    buffer_load_dwordx4 v10, s[40:43], s31 offen lds
    s_add_u32 m0, s77, 1024
    s_add_u32 s31, s75, 16384
    buffer_load_dwordx4 v11, s[40:43], s31 offen lds
    s_add_u32 m0, s77, 2048
    s_add_u32 s31, s75, 32768
    buffer_load_dwordx4 v10, s[40:43], s31 offen lds
    s_add_u32 m0, s77, 3072
    s_add_u32 s31, s75, 49152
    buffer_load_dwordx4 v11, s[40:43], s31 offen lds
    s_add_u32 m0, s77, 4096
    s_add_u32 s31, s75, 65536
    buffer_load_dwordx4 v10, s[40:43], s31 offen lds
    s_add_u32 m0, s77, 5120
    s_add_u32 s31, s75, 81920
    buffer_load_dwordx4 v11, s[40:43], s31 offen lds
    s_add_u32 m0, s77, 6144
    s_add_u32 s31, s75, 98304
    buffer_load_dwordx4 v10, s[40:43], s31 offen lds
    s_add_u32 m0, s77, 7168
    s_add_u32 s31, s75, 114688
    buffer_load_dwordx4 v11, s[40:43], s31 offen lds
    s_add_u32 m0, s78, 0
    s_add_u32 s31, s76, 198656
    buffer_load_dwordx4 v12, s[44:47], s31 offen lds
    s_add_u32 m0, s78, 1024
    s_add_u32 s31, s76, 247808
    buffer_load_dwordx4 v12, s[44:47], s31 offen lds
    s_add_u32 m0, s78, 2048
    s_add_u32 s31, s76, 296960
    buffer_load_dwordx4 v12, s[44:47], s31 offen lds
    s_add_u32 m0, s78, 3072
    s_add_u32 s31, s76, 346112
    buffer_load_dwordx4 v12, s[44:47], s31 offen lds
    s_add_u32 m0, s78, 4096
    s_add_u32 s31, s76, 4096
    buffer_load_dwordx4 v12, s[44:47], s31 offen lds
    s_add_u32 m0, s78, 5120
    s_add_u32 s31, s76, 53248
    buffer_load_dwordx4 v12, s[44:47], s31 offen lds
    s_add_u32 m0, s78, 6144
    s_add_u32 s31, s76, 102400
    buffer_load_dwordx4 v12, s[44:47], s31 offen lds
    s_add_u32 m0, s78, 7168
    s_add_u32 s31, s76, 151552
    buffer_load_dwordx4 v12, s[44:47], s31 offen lds
    s_add_u32 m0, s78, 8192
    s_add_u32 s31, s76, 200704
    buffer_load_dwordx4 v12, s[44:47], s31 offen lds
    s_add_u32 m0, s78, 9216
    s_add_u32 s31, s76, 249856
    buffer_load_dwordx4 v12, s[44:47], s31 offen lds
    s_add_u32 m0, s78, 10240
    s_add_u32 s31, s76, 299008
    buffer_load_dwordx4 v12, s[44:47], s31 offen lds
    s_add_u32 m0, s78, 11264
    s_add_u32 s31, s76, 348160
    buffer_load_dwordx4 v12, s[44:47], s31 offen lds
    s_add_u32 s72, s72, 1
    s_cmp_eq_u32 s73, 0
    s_cselect_b32 s73, 122880, s73
    s_sub_u32 s73, s73, 40960
    s_waitcnt vmcnt(20)
    s_barrier
    s_add_u32 s79, s79, 1
    s_cmp_lt_u32 s79, 14
    s_cbranch_scc1 L_dl_10
    s_branch L_convdma_6
L_roleP_4:
    s_lshl_b32 s31, s2, 4
    s_add_u32 s31, s31, s28
    s_cmp_lg_u32 s31, 6
    s_cbranch_scc1 L_notag_11
    s_memrealtime s[60:61]
    s_waitcnt lgkmcnt(0)
    s_or_b32 s60, s60, 1
    v_mov_b32 v2, s60
    v_mov_b32 v4, 0
    s_mov_b64 exec, 1
    buffer_store_dword v2, v4, s[32:35], 0 offen sc1
    s_mov_b64 exec, -1
L_notag_11:
    s_lshr_b32 s8, s2, 3
    v_lshrrev_b32 v6, 1, v0
    v_lshlrev_b32 v6, 11, v6
    v_and_b32 v7, 1, v0
    v_lshl_add_u32 v6, v7, 7, v6
    s_and_b32 s31, s2, 1
    s_lshl_b32 s31, s31, 10
    s_lshl_b32 s60, s8, 5
    s_add_u32 s31, s31, s60
    s_lshl_b32 s62, s31, 11
    v_lshrrev_b32 v8, 5, v0
    v_mul_u32_u24 v8, 393216, v8
    v_bfe_u32 v7, v0, 4, 1
    v_mul_u32_u24 v7, 6144, v7
    v_add_u32 v8, v8, v7
    v_bfe_u32 v7, v0, 2, 2
    v_min_u32 v7, 2, v7
    v_lshl_add_u32 v8, v7, 11, v8
    v_and_b32 v7, 3, v0
    v_lshl_add_u32 v8, v7, 7, v8
    s_lshl_b32 s8, s8, 1
    s_mul_i32 s63, s8, 6144
    s_bfe_u32 s31, s2, 0x20001
    s_lshl_b32 s31, s31, 9
    s_add_u32 s63, s63, s31
    s_cmp_eq_u32 s28, 6
    s_cselect_b32 s88, s40, s44
    s_cselect_b32 s89, s41, s45
    s_cselect_b32 s90, s42, s46
    s_mov_b32 s91, 0x00020000
    s_cselect_b32 s62, s62, s63
    s_mov_b32 s31, 786432
    s_cselect_b32 s65, 256, s31
    s_cselect_b64 vcc, -1, 0
    v_cndmask_b32 v6, v8, v6, vcc
    s_add_u32 s62, s62, s65
    buffer_load_dword v9, v6, s[88:91], s62 offen sc1
    s_mul_i32 s66, s2, 16896
    s_add_u32 s66, s66, 16777216
    s_lshl_b32 s67, s2, 14
    s_barrier
    s_add_u32 s62, s62, s65
    buffer_load_dword v9, v6, s[88:91], s62 offen sc1
    s_barrier
    s_barrier
    s_add_u32 s62, s62, s65
    buffer_load_dword v9, v6, s[88:91], s62 offen sc1
    s_barrier
    v_lshlrev_b32 v10, 7, v0
    s_and_b32 s31, s28, 1
    s_lshl_b32 s31, s31, 13
    s_add_u32 s31, s31, s67
    buffer_load_dword v9, v10, s[16:19], s31 offen sc1
    v_mov_b32 v2, 0
    s_mov_b32 s95, 0
L_tag_12:
    buffer_load_dword v3, v2, s[32:35], 0 offen sc1
    s_add_u32 s95, s95, 1
    s_waitcnt vmcnt(0)
    v_readfirstlane_b32 s9, v3
    s_nop 3
    s_cmp_lg_u32 s9, 0
    s_cbranch_scc1 L_tagd_13
    s_sleep 4
    s_cmp_lt_u32 s95, 0x400000
    s_cbranch_scc1 L_tag_12
L_tagd_13:
    s_barrier
    s_add_u32 s62, s62, s65
    buffer_load_dword v9, v6, s[88:91], s62 offen sc1
    s_barrier
    s_barrier
    s_add_u32 s62, s62, s65
    buffer_load_dword v9, v6, s[88:91], s62 offen sc1
    s_barrier
    s_barrier
    s_add_u32 s62, s62, s65
    buffer_load_dword v9, v6, s[88:91], s62 offen sc1
    s_barrier
    s_barrier
    s_add_u32 s62, s62, s65
    buffer_load_dword v9, v6, s[88:91], s62 offen sc1
    s_barrier
    s_lshr_b32 s68, s2, 4
    s_lshl_b32 s94, s68, 8
    s_add_u32 s94, s94, 31526912
    v_and_b32 v8, 15, v0
    v_lshlrev_b32 v8, 2, v8
    s_mov_b32 s95, 0
L_poll_14:
    buffer_load_dword v9, v8, s[12:15], s94 offen sc1
    s_add_u32 s95, s95, 1
    s_waitcnt vmcnt(0)
    v_cmp_ne_u32 vcc, s9, v9
    s_cmp_eq_u64 vcc, 0
    s_cbranch_scc1 L_polld_15
    s_sleep 4
    s_cmp_lt_u32 s95, 0x400000
    s_cbranch_scc1 L_poll_14
L_polld_15:
    s_bitcmp1_b32 s28, 0
    s_cbranch_scc1 L_w7_16
    s_mov_b32 m0, 122880
    s_add_u32 s31, s66, 0
    buffer_load_dwordx4 v1, s[12:15], s31 offen sc1 lds
    s_mov_b32 m0, 123904
    s_add_u32 s31, s66, 1024
    buffer_load_dwordx4 v1, s[12:15], s31 offen sc1 lds
    s_mov_b32 m0, 124928
    s_add_u32 s31, s66, 2048
    buffer_load_dwordx4 v1, s[12:15], s31 offen sc1 lds
    s_mov_b32 m0, 125952
    s_add_u32 s31, s66, 3072
    buffer_load_dwordx4 v1, s[12:15], s31 offen sc1 lds
    s_mov_b32 s31, 41943040
    s_mov_b64 exec, 15
    s_mov_b32 m0, 126976
    s_nop 0
    buffer_load_dwordx4 v1, s[12:15], s31 offen lds
    s_mov_b64 exec, -1
    s_mov_b32 m0, 127552
    s_add_u32 s31, s67, 0
    buffer_load_dwordx4 v1, s[16:19], s31 offen lds
    s_mov_b32 m0, 128576
    s_add_u32 s31, s67, 1024
    buffer_load_dwordx4 v1, s[16:19], s31 offen lds
    s_mov_b32 m0, 129600
    s_add_u32 s31, s67, 2048
    buffer_load_dwordx4 v1, s[16:19], s31 offen lds
    s_mov_b32 m0, 130624
    s_add_u32 s31, s67, 3072
    buffer_load_dwordx4 v1, s[16:19], s31 offen lds
    s_mov_b32 s31, 41943040
    s_mov_b32 exec_hi, 0
    s_mov_b32 m0, 127040
    s_nop 0
    buffer_load_dwordx4 v1, s[12:15], s31 offen lds
    s_mov_b64 exec, -1
    s_mov_b32 m0, 131648
    s_add_u32 s31, s66, 4224
    buffer_load_dwordx4 v1, s[12:15], s31 offen sc1 lds
    s_mov_b32 m0, 132672
    s_add_u32 s31, s66, 5248
    buffer_load_dwordx4 v1, s[12:15], s31 offen sc1 lds
    s_mov_b32 m0, 133696
    s_add_u32 s31, s66, 6272
    buffer_load_dwordx4 v1, s[12:15], s31 offen sc1 lds
    s_mov_b32 m0, 134720
    s_add_u32 s31, s66, 7296
    buffer_load_dwordx4 v1, s[12:15], s31 offen sc1 lds
    s_mov_b32 s31, 41943040
    s_mov_b64 exec, 15
    s_mov_b32 m0, 135744
    s_nop 0
    buffer_load_dwordx4 v1, s[12:15], s31 offen lds
    s_mov_b64 exec, -1
    s_mov_b32 m0, 136320
    s_add_u32 s31, s67, 4096
    buffer_load_dwordx4 v1, s[16:19], s31 offen lds
    s_mov_b32 m0, 137344
    s_add_u32 s31, s67, 5120
    buffer_load_dwordx4 v1, s[16:19], s31 offen lds
    s_mov_b32 m0, 138368
    s_add_u32 s31, s67, 6144
    buffer_load_dwordx4 v1, s[16:19], s31 offen lds
    s_mov_b32 m0, 139392
    s_add_u32 s31, s67, 7168
    buffer_load_dwordx4 v1, s[16:19], s31 offen lds
    s_mov_b32 s31, 41943040
    s_mov_b32 exec_hi, 0
    s_mov_b32 m0, 135808
    s_nop 0
    buffer_load_dwordx4 v1, s[12:15], s31 offen lds
    s_mov_b64 exec, -1
    s_branch L_we_17
L_w7_16:
    s_mov_b32 m0, 140416
    s_add_u32 s31, s66, 8448
    buffer_load_dwordx4 v1, s[12:15], s31 offen sc1 lds
    s_mov_b32 m0, 141440
    s_add_u32 s31, s66, 9472
    buffer_load_dwordx4 v1, s[12:15], s31 offen sc1 lds
    s_mov_b32 m0, 142464
    s_add_u32 s31, s66, 10496
    buffer_load_dwordx4 v1, s[12:15], s31 offen sc1 lds
    s_mov_b32 m0, 143488
    s_add_u32 s31, s66, 11520
    buffer_load_dwordx4 v1, s[12:15], s31 offen sc1 lds
    s_mov_b32 s31, 41943040
    s_mov_b64 exec, 15
    s_mov_b32 m0, 144512
    s_nop 0
    buffer_load_dwordx4 v1, s[12:15], s31 offen lds
    s_mov_b64 exec, -1
    s_mov_b32 m0, 145088
    s_add_u32 s31, s67, 8192
    buffer_load_dwordx4 v1, s[16:19], s31 offen lds
    s_mov_b32 m0, 146112
    s_add_u32 s31, s67, 9216
    buffer_load_dwordx4 v1, s[16:19], s31 offen lds
    s_mov_b32 m0, 147136
    s_add_u32 s31, s67, 10240
    buffer_load_dwordx4 v1, s[16:19], s31 offen lds
    s_mov_b32 m0, 148160
    s_add_u32 s31, s67, 11264
    buffer_load_dwordx4 v1, s[16:19], s31 offen lds
    s_mov_b32 s31, 41943040
    s_mov_b32 exec_hi, 0
    s_mov_b32 m0, 144576
    s_nop 0
    buffer_load_dwordx4 v1, s[12:15], s31 offen lds
    s_mov_b64 exec, -1
    s_mov_b32 m0, 149184
    s_add_u32 s31, s66, 12672
    buffer_load_dwordx4 v1, s[12:15], s31 offen sc1 lds
    s_mov_b32 m0, 150208
    s_add_u32 s31, s66, 13696
    buffer_load_dwordx4 v1, s[12:15], s31 offen sc1 lds
    s_mov_b32 m0, 151232
    s_add_u32 s31, s66, 14720
    buffer_load_dwordx4 v1, s[12:15], s31 offen sc1 lds
    s_mov_b32 m0, 152256
    s_add_u32 s31, s66, 15744
    buffer_load_dwordx4 v1, s[12:15], s31 offen sc1 lds
    s_mov_b32 s31, 41943040
    s_mov_b64 exec, 15
    s_mov_b32 m0, 153280
    s_nop 0
    buffer_load_dwordx4 v1, s[12:15], s31 offen lds
    s_mov_b64 exec, -1
    s_mov_b32 m0, 153856
    s_add_u32 s31, s67, 12288
    buffer_load_dwordx4 v1, s[16:19], s31 offen lds
    s_mov_b32 m0, 154880
    s_add_u32 s31, s67, 13312
    buffer_load_dwordx4 v1, s[16:19], s31 offen lds
    s_mov_b32 m0, 155904
    s_add_u32 s31, s67, 14336
    buffer_load_dwordx4 v1, s[16:19], s31 offen lds
    s_mov_b32 m0, 156928
    s_add_u32 s31, s67, 15360
    buffer_load_dwordx4 v1, s[16:19], s31 offen lds
    s_mov_b32 s31, 41943040
    s_mov_b32 exec_hi, 0
    s_mov_b32 m0, 153344
    s_nop 0
    buffer_load_dwordx4 v1, s[12:15], s31 offen lds
    s_mov_b64 exec, -1
L_we_17:
    s_barrier
    s_barrier
    s_barrier
    s_barrier
    s_waitcnt vmcnt(0)
    s_branch L_conv_7
L_convdma_6:
    s_waitcnt vmcnt(0)
    s_barrier
    s_branch L_conv_7
L_roleC_2:
    s_and_b32 s60, s28, 1
    s_lshr_b32 s61, s28, 1
    v_and_b32 v56, 31, v0
    v_lshrrev_b32 v2, 5, v0
    v_lshrrev_b32 v3, 1, v56
    v_and_b32 v3, 7, v3
    s_lshl_b32 s62, s60, 13
    v_lshlrev_b32 v9, 7, v56
    v_add_u32 v9, s62, v9
    v_or_b32 v15, 0, v2
    v_xor_b32 v15, v15, v3
    v_lshl_add_u32 v4, v15, 4, v9
    v_or_b32 v15, 2, v2
    v_xor_b32 v15, v15, v3
    v_lshl_add_u32 v5, v15, 4, v9
    v_or_b32 v15, 4, v2
    v_xor_b32 v15, v15, v3
    v_lshl_add_u32 v6, v15, 4, v9
    v_or_b32 v15, 6, v2
    v_xor_b32 v15, v15, v3
    v_lshl_add_u32 v7, v15, 4, v9
    v_and_b32 v56, 15, v0
    v_lshrrev_b32 v3, 2, v56
    v_and_b32 v56, 3, v56
    v_lshrrev_b32 v15, 4, v0
    v_and_b32 v15, 1, v15
    v_lshlrev_b32 v15, 5, v15
    v_lshl_add_u32 v15, v56, 3, v15
    s_lshl_b32 s62, s61, 6
    v_add_u32 v15, s62, v15
    v_lshrrev_b32 v56, 1, v3
    v_and_b32 v56, 1, v56
    v_lshlrev_b32 v56, 6, v56
    v_xor_b32 v15, v15, v56
    v_lshl_add_u32 v3, v2, 3, v3
    v_lshl_add_u32 v8, v3, 7, v15
    v_add_u32 v8, 16384, v8
    v_mov_b32 v10, v4
    v_mov_b32 v11, v5
    v_mov_b32 v12, v6
    v_mov_b32 v13, v7
    v_mov_b32 v14, v8
    v_mov_b32 v64, 0
    v_mov_b32 v65, 0
    v_mov_b32 v66, 0
    v_mov_b32 v67, 0
    v_mov_b32 v68, 0
    v_mov_b32 v69, 0
    v_mov_b32 v70, 0
    v_mov_b32 v71, 0
    v_mov_b32 v72, 0
    v_mov_b32 v73, 0
    v_mov_b32 v74, 0
    v_mov_b32 v75, 0
    v_mov_b32 v76, 0
    v_mov_b32 v77, 0
    v_mov_b32 v78, 0
    v_mov_b32 v79, 0
    v_mov_b32 v80, 0
    v_mov_b32 v81, 0
    v_mov_b32 v82, 0
    v_mov_b32 v83, 0
    v_mov_b32 v84, 0
    v_mov_b32 v85, 0
    v_mov_b32 v86, 0
    v_mov_b32 v87, 0
    v_mov_b32 v88, 0
    v_mov_b32 v89, 0
    v_mov_b32 v90, 0
    v_mov_b32 v91, 0
    v_mov_b32 v92, 0
    v_mov_b32 v93, 0
    v_mov_b32 v94, 0
    v_mov_b32 v95, 0
    v_mov_b32 v96, 0
    v_mov_b32 v97, 0
    v_mov_b32 v98, 0
    v_mov_b32 v99, 0
    v_mov_b32 v100, 0
    v_mov_b32 v101, 0
    v_mov_b32 v102, 0
    v_mov_b32 v103, 0
    v_mov_b32 v104, 0
    v_mov_b32 v105, 0
    v_mov_b32 v106, 0
    v_mov_b32 v107, 0
    v_mov_b32 v108, 0
    v_mov_b32 v109, 0
    v_mov_b32 v110, 0
    v_mov_b32 v111, 0
    v_mov_b32 v112, 0
    v_mov_b32 v113, 0
    v_mov_b32 v114, 0
    v_mov_b32 v115, 0
    v_mov_b32 v116, 0
    v_mov_b32 v117, 0
    v_mov_b32 v118, 0
    v_mov_b32 v119, 0
    v_mov_b32 v120, 0
    v_mov_b32 v121, 0
    v_mov_b32 v122, 0
    v_mov_b32 v123, 0
    v_mov_b32 v124, 0
    v_mov_b32 v125, 0
    v_mov_b32 v126, 0
    v_mov_b32 v127, 0
    v_mov_b32 v128, 0
    v_mov_b32 v129, 0
    v_mov_b32 v130, 0
    v_mov_b32 v131, 0
    v_mov_b32 v132, 0
    v_mov_b32 v133, 0
    v_mov_b32 v134, 0
    v_mov_b32 v135, 0
    v_mov_b32 v136, 0
    v_mov_b32 v137, 0
    v_mov_b32 v138, 0
    v_mov_b32 v139, 0
    v_mov_b32 v140, 0
    v_mov_b32 v141, 0
    v_mov_b32 v142, 0
    v_mov_b32 v143, 0
    v_mov_b32 v144, 0
    v_mov_b32 v145, 0
    v_mov_b32 v146, 0
    v_mov_b32 v147, 0
    v_mov_b32 v148, 0
    v_mov_b32 v149, 0
    v_mov_b32 v150, 0
    v_mov_b32 v151, 0
    v_mov_b32 v152, 0
    v_mov_b32 v153, 0
    v_mov_b32 v154, 0
    v_mov_b32 v155, 0
    v_mov_b32 v156, 0
    v_mov_b32 v157, 0
    v_mov_b32 v158, 0
    v_mov_b32 v159, 0
    s_mov_b32 s72, 0
    s_mov_b32 s73, 0
    s_barrier
    ds_read_b128 v[16:19], v10 offset:0
    ds_read_b128 v[20:23], v10 offset:4096
    ds_read_b64_tr_b16 v[32:33], v14 offset:0
    ds_read_b64_tr_b16 v[34:35], v14 offset:512
    ds_read_b64_tr_b16 v[36:37], v14 offset:8192
    ds_read_b64_tr_b16 v[38:39], v14 offset:8704
    ds_read_b64_tr_b16 v[40:41], v14 offset:16384
    ds_read_b64_tr_b16 v[42:43], v14 offset:16896
L_stage_18:
    s_waitcnt lgkmcnt(0)
    v_mfma_f32_32x32x16_bf16 v[64:79], v[32:35], v[16:19], v[64:79]
    ds_read_b128 v[24:27], v11 offset:0
    ds_read_b128 v[28:31], v11 offset:4096
    ds_read_b64_tr_b16 v[44:45], v14 offset:2048
    ds_read_b64_tr_b16 v[46:47], v14 offset:2560
    v_mfma_f32_32x32x16_bf16 v[80:95], v[36:39], v[16:19], v[80:95]
    ds_read_b64_tr_b16 v[48:49], v14 offset:10240
    ds_read_b64_tr_b16 v[50:51], v14 offset:10752
    ds_read_b64_tr_b16 v[52:53], v14 offset:18432
    ds_read_b64_tr_b16 v[54:55], v14 offset:18944
    v_mfma_f32_32x32x16_bf16 v[96:111], v[16:19], v[40:43], v[96:111]
    v_mfma_f32_32x32x16_bf16 v[112:127], v[32:35], v[20:23], v[112:127]
    v_mfma_f32_32x32x16_bf16 v[128:143], v[36:39], v[20:23], v[128:143]
    v_mfma_f32_32x32x16_bf16 v[144:159], v[20:23], v[40:43], v[144:159]
    s_waitcnt lgkmcnt(0)
    v_mfma_f32_32x32x16_bf16 v[64:79], v[44:47], v[24:27], v[64:79]
    ds_read_b128 v[16:19], v12 offset:0
    ds_read_b128 v[20:23], v12 offset:4096
    ds_read_b64_tr_b16 v[32:33], v14 offset:4096
    ds_read_b64_tr_b16 v[34:35], v14 offset:4608
    v_mfma_f32_32x32x16_bf16 v[80:95], v[48:51], v[24:27], v[80:95]
    ds_read_b64_tr_b16 v[36:37], v14 offset:12288
    ds_read_b64_tr_b16 v[38:39], v14 offset:12800
    ds_read_b64_tr_b16 v[40:41], v14 offset:20480
    ds_read_b64_tr_b16 v[42:43], v14 offset:20992
    v_mfma_f32_32x32x16_bf16 v[96:111], v[24:27], v[52:55], v[96:111]
    v_mfma_f32_32x32x16_bf16 v[112:127], v[44:47], v[28:31], v[112:127]
    v_mfma_f32_32x32x16_bf16 v[128:143], v[48:51], v[28:31], v[128:143]
    v_mfma_f32_32x32x16_bf16 v[144:159], v[28:31], v[52:55], v[144:159]
    s_waitcnt lgkmcnt(0)
    v_mfma_f32_32x32x16_bf16 v[64:79], v[32:35], v[16:19], v[64:79]
    ds_read_b128 v[24:27], v13 offset:0
    ds_read_b128 v[28:31], v13 offset:4096
    ds_read_b64_tr_b16 v[44:45], v14 offset:6144
    ds_read_b64_tr_b16 v[46:47], v14 offset:6656
    v_mfma_f32_32x32x16_bf16 v[80:95], v[36:39], v[16:19], v[80:95]
    ds_read_b64_tr_b16 v[48:49], v14 offset:14336
    ds_read_b64_tr_b16 v[50:51], v14 offset:14848
    ds_read_b64_tr_b16 v[52:53], v14 offset:22528
    ds_read_b64_tr_b16 v[54:55], v14 offset:23040
    v_mfma_f32_32x32x16_bf16 v[96:111], v[16:19], v[40:43], v[96:111]
    v_mfma_f32_32x32x16_bf16 v[112:127], v[32:35], v[20:23], v[112:127]
    v_mfma_f32_32x32x16_bf16 v[128:143], v[36:39], v[20:23], v[128:143]
    v_mfma_f32_32x32x16_bf16 v[144:159], v[20:23], v[40:43], v[144:159]
    s_waitcnt lgkmcnt(0)
    s_cmp_eq_u32 s72, 15
    s_cbranch_scc1 L_last_19
    s_barrier
    s_cmp_eq_u32 s73, 0
    s_cselect_b32 s73, 122880, s73
    s_sub_u32 s73, s73, 40960
    v_add_u32 v10, s73, v4
    v_add_u32 v11, s73, v5
    v_add_u32 v12, s73, v6
    v_add_u32 v13, s73, v7
    v_add_u32 v14, s73, v8
    ds_read_b128 v[16:19], v10 offset:0
    ds_read_b128 v[20:23], v10 offset:4096
    ds_read_b64_tr_b16 v[32:33], v14 offset:0
    ds_read_b64_tr_b16 v[34:35], v14 offset:512
    ds_read_b64_tr_b16 v[36:37], v14 offset:8192
    ds_read_b64_tr_b16 v[38:39], v14 offset:8704
    ds_read_b64_tr_b16 v[40:41], v14 offset:16384
    ds_read_b64_tr_b16 v[42:43], v14 offset:16896
    v_mfma_f32_32x32x16_bf16 v[64:79], v[44:47], v[24:27], v[64:79]
    v_mfma_f32_32x32x16_bf16 v[80:95], v[48:51], v[24:27], v[80:95]
    v_mfma_f32_32x32x16_bf16 v[96:111], v[24:27], v[52:55], v[96:111]
    v_mfma_f32_32x32x16_bf16 v[112:127], v[44:47], v[28:31], v[112:127]
    v_mfma_f32_32x32x16_bf16 v[128:143], v[48:51], v[28:31], v[128:143]
    v_mfma_f32_32x32x16_bf16 v[144:159], v[28:31], v[52:55], v[144:159]
    s_add_u32 s72, s72, 1
    s_branch L_stage_18
L_last_19:
    v_mfma_f32_32x32x16_bf16 v[64:79], v[44:47], v[24:27], v[64:79]
    v_mfma_f32_32x32x16_bf16 v[80:95], v[48:51], v[24:27], v[80:95]
    v_mfma_f32_32x32x16_bf16 v[96:111], v[24:27], v[52:55], v[96:111]
    v_mfma_f32_32x32x16_bf16 v[112:127], v[44:47], v[28:31], v[112:127]
    v_mfma_f32_32x32x16_bf16 v[128:143], v[48:51], v[28:31], v[128:143]
    v_mfma_f32_32x32x16_bf16 v[144:159], v[28:31], v[52:55], v[144:159]
    v_mov_b32 v56, 0
    buffer_load_dword v57, v56, s[32:35], 0 offen sc1
    s_nop 15
    s_lshl_b32 s62, s6, 1
    s_add_u32 s62, s62, s61
    s_lshl_b32 s63, s5, 2
    s_lshl_b32 s64, s60, 1
    s_add_u32 s63, s63, s64
    s_lshl_b32 s64, s62, 6
    s_add_u32 s64, s64, s63
    s_lshl_b32 s64, s64, 11
    s_mov_b32 s66, 1048744942
    v_cvt_pk_bf16_f32 v80, v80, v81
    v_cvt_pk_bf16_f32 v81, v82, v83
    v_cvt_pk_bf16_f32 v82, v84, v85
    v_cvt_pk_bf16_f32 v83, v86, v87
    v_cvt_pk_bf16_f32 v84, v88, v89
    v_cvt_pk_bf16_f32 v85, v90, v91
    v_cvt_pk_bf16_f32 v86, v92, v93
    v_cvt_pk_bf16_f32 v87, v94, v95
    s_add_u32 s65, s64, 4194304
    buffer_store_dwordx4 v[80:83], v1, s[12:15], s65 offen sc1
    buffer_store_dwordx4 v[84:87], v1, s[12:15], s65 offen offset:1024 sc1
    v_cvt_pk_bf16_f32 v128, v128, v129
    v_cvt_pk_bf16_f32 v129, v130, v131
    v_cvt_pk_bf16_f32 v130, v132, v133
    v_cvt_pk_bf16_f32 v131, v134, v135
    v_cvt_pk_bf16_f32 v132, v136, v137
    v_cvt_pk_bf16_f32 v133, v138, v139
    v_cvt_pk_bf16_f32 v134, v140, v141
    v_cvt_pk_bf16_f32 v135, v142, v143
    s_add_u32 s65, s64, 4196352
    buffer_store_dwordx4 v[128:131], v1, s[12:15], s65 offen sc1
    buffer_store_dwordx4 v[132:135], v1, s[12:15], s65 offen offset:1024 sc1
    v_cvt_pk_bf16_f32 v96, v96, v97
    v_cvt_pk_bf16_f32 v97, v98, v99
    v_cvt_pk_bf16_f32 v98, v100, v101
    v_cvt_pk_bf16_f32 v99, v102, v103
    v_cvt_pk_bf16_f32 v100, v104, v105
    v_cvt_pk_bf16_f32 v101, v106, v107
    v_cvt_pk_bf16_f32 v102, v108, v109
    v_cvt_pk_bf16_f32 v103, v110, v111
    s_add_u32 s65, s64, 8388608
    buffer_store_dwordx4 v[96:99], v1, s[12:15], s65 offen sc1
    buffer_store_dwordx4 v[100:103], v1, s[12:15], s65 offen offset:1024 sc1
    v_cvt_pk_bf16_f32 v144, v144, v145
    v_cvt_pk_bf16_f32 v145, v146, v147
    v_cvt_pk_bf16_f32 v146, v148, v149
    v_cvt_pk_bf16_f32 v147, v150, v151
    v_cvt_pk_bf16_f32 v148, v152, v153
    v_cvt_pk_bf16_f32 v149, v154, v155
    v_cvt_pk_bf16_f32 v150, v156, v157
    v_cvt_pk_bf16_f32 v151, v158, v159
    s_add_u32 s65, s64, 8390656
    buffer_store_dwordx4 v[144:147], v1, s[12:15], s65 offen sc1
    buffer_store_dwordx4 v[148:151], v1, s[12:15], s65 offen offset:1024 sc1
    v_mul_f32 v64, s66, v64
    v_mul_f32 v65, s66, v65
    v_mul_f32 v66, s66, v66
    v_mul_f32 v67, s66, v67
    v_mul_f32 v68, s66, v68
    v_mul_f32 v69, s66, v69
    v_mul_f32 v70, s66, v70
    v_mul_f32 v71, s66, v71
    v_mul_f32 v72, s66, v72
    v_mul_f32 v73, s66, v73
    v_mul_f32 v74, s66, v74
    v_mul_f32 v75, s66, v75
    v_mul_f32 v76, s66, v76
    v_mul_f32 v77, s66, v77
    v_mul_f32 v78, s66, v78
    v_mul_f32 v79, s66, v79
    v_cvt_pk_bf16_f32 v64, v64, v65
    v_cvt_pk_bf16_f32 v65, v66, v67
    v_cvt_pk_bf16_f32 v66, v68, v69
    v_cvt_pk_bf16_f32 v67, v70, v71
    v_cvt_pk_bf16_f32 v68, v72, v73
    v_cvt_pk_bf16_f32 v69, v74, v75
    v_cvt_pk_bf16_f32 v70, v76, v77
    v_cvt_pk_bf16_f32 v71, v78, v79
    s_add_u32 s65, s64, 0
    buffer_store_dwordx4 v[64:67], v1, s[12:15], s65 offen sc1
    buffer_store_dwordx4 v[68:71], v1, s[12:15], s65 offen offset:1024 sc1
    v_mul_f32 v112, s66, v112
    v_mul_f32 v113, s66, v113
    v_mul_f32 v114, s66, v114
    v_mul_f32 v115, s66, v115
    v_mul_f32 v116, s66, v116
    v_mul_f32 v117, s66, v117
    v_mul_f32 v118, s66, v118
    v_mul_f32 v119, s66, v119
    v_mul_f32 v120, s66, v120
    v_mul_f32 v121, s66, v121
    v_mul_f32 v122, s66, v122
    v_mul_f32 v123, s66, v123
    v_mul_f32 v124, s66, v124
    v_mul_f32 v125, s66, v125
    v_mul_f32 v126, s66, v126
    v_mul_f32 v127, s66, v127
    v_cvt_pk_bf16_f32 v112, v112, v113
    v_cvt_pk_bf16_f32 v113, v114, v115
    v_cvt_pk_bf16_f32 v114, v116, v117
    v_cvt_pk_bf16_f32 v115, v118, v119
    v_cvt_pk_bf16_f32 v116, v120, v121
    v_cvt_pk_bf16_f32 v117, v122, v123
    v_cvt_pk_bf16_f32 v118, v124, v125
    v_cvt_pk_bf16_f32 v119, v126, v127
    s_add_u32 s65, s64, 2048
    buffer_store_dwordx4 v[112:115], v1, s[12:15], s65 offen sc1
    buffer_store_dwordx4 v[116:119], v1, s[12:15], s65 offen offset:1024 sc1
    v_dot2_f32_bf16 v16, v80, v80, 0
    v_dot2_f32_bf16 v16, v81, v81, v16
    v_dot2_f32_bf16 v16, v82, v82, v16
    v_dot2_f32_bf16 v16, v83, v83, v16
    v_dot2_f32_bf16 v16, v84, v84, v16
    v_dot2_f32_bf16 v16, v85, v85, v16
    v_dot2_f32_bf16 v16, v86, v86, v16
    v_dot2_f32_bf16 v16, v87, v87, v16
    v_dot2_f32_bf16 v17, v128, v128, 0
    v_dot2_f32_bf16 v17, v129, v129, v17
    v_dot2_f32_bf16 v17, v130, v130, v17
    v_dot2_f32_bf16 v17, v131, v131, v17
    v_dot2_f32_bf16 v17, v132, v132, v17
    v_dot2_f32_bf16 v17, v133, v133, v17
    v_dot2_f32_bf16 v17, v134, v134, v17
    v_dot2_f32_bf16 v17, v135, v135, v17
    s_nop 3
    v_mov_b32 v18, v16
    v_mov_b32 v19, v17
    s_nop 1
    v_permlane32_swap_b32 v18, v16
    v_permlane32_swap_b32 v19, v17
    s_nop 1
    v_add_f32 v16, v16, v18
    v_add_f32 v17, v17, v19
    v_max_f32 v16, v16, v17
    s_nop 1
    v_max_f32_dpp v16, v16, v16 quad_perm:[1,0,3,2] row_mask:0xf bank_mask:0xf
    s_nop 1
    v_max_f32_dpp v16, v16, v16 quad_perm:[2,3,0,1] row_mask:0xf bank_mask:0xf
    s_nop 1
    v_max_f32_dpp v16, v16, v16 row_half_mirror row_mask:0xf bank_mask:0xf
    s_nop 1
    v_max_f32_dpp v16, v16, v16 row_mirror row_mask:0xf bank_mask:0xf
    s_nop 1
    v_mov_b32 v17, v16
    s_nop 1
    v_permlane16_swap_b32 v17, v16
    s_nop 1
    v_max_f32 v16, v16, v17
    s_lshl_b32 s64, s62, 5
    s_lshl_b32 s65, s5, 1
    s_add_u32 s64, s64, s65
    s_add_u32 s64, s64, s60
    s_lshl_b32 s64, s64, 2
    s_add_u32 s64, s64, 31457280
    s_mov_b64 exec, 1
    buffer_store_dword v16, v56, s[12:15], s64 offen sc1
    s_mov_b64 exec, -1
    s_mov_b32 s86, s62
    s_lshl_b32 s87, s5, 1
    s_add_u32 s87, s87, s60
    s_waitcnt vmcnt(13)
    v_readfirstlane_b32 s9, v57
L_conv_7:
    s_and_b32 s60, s28, 3
    s_lshr_b32 s61, s28, 2
    s_lshl_b32 s62, s2, 2
    s_add_u32 s62, s62, s60
    s_mov_b32 s63, 122880
    s_mov_b32 s65, 127040
    s_mov_b32 s68, 65600
    s_cmp_eq_u32 s60, 1
    s_cselect_b32 s63, 131648, s63
    s_cselect_b32 s65, 135808, s65
    s_cselect_b32 s68, 78208, s68
    s_cmp_eq_u32 s60, 2
    s_cselect_b32 s63, 140416, s63
    s_cselect_b32 s65, 144576, s65
    s_cselect_b32 s68, 90816, s68
    s_cmp_eq_u32 s60, 3
    s_cselect_b32 s63, 149184, s63
    s_cselect_b32 s65, 153344, s65
    s_cselect_b32 s68, 103424, s68
    s_lshr_b32 s31, s62, 1
    s_lshl_b32 s31, s31, 2
    s_add_u32 s66, s10, s31
    s_addc_u32 s67, s11, 0
    s_load_dword s70, s[66:67], 0
    v_and_b32 v2, 15, v0
    v_lshrrev_b32 v3, 4, v0
    v_sub_u32 v4, 3, v2
    v_and_b32 v4, 3, v4
    v_cmp_eq_u32 vcc, 0, v4
    v_mul_u32_u24 v4, 4160, v4
    s_sub_u32 s31, s68, 4160
    v_add_u32 v4, s31, v4
    v_mov_b32 v5, s63
    v_cndmask_b32 v4, v4, v5, vcc
    v_lshrrev_b32 v5, 2, v2
    v_lshlrev_b32 v6, 1, v3
    v_sub_u32 v5, v6, v5
    v_add_u32 v5, 3, v5
    v_lshl_add_u32 v4, v5, 3, v4
    v_lshlrev_b32 v5, 5, v2
    v_lshl_add_u32 v5, v3, 4, v5
    s_add_u32 s31, s65, 32
    v_add_u32 v5, s31, v5
    v_lshlrev_b32 v6, 5, v2
    v_lshl_add_u32 v6, v3, 3, v6
    s_add_u32 s31, s63, 504
    v_sub_u32 v7, s31, v6
    s_lshl_b32 s64, s62, 12
    s_add_u32 s64, s64, 27262976
    s_waitcnt lgkmcnt(0)
    s_lshl_b32 s31, s61, 11
    v_lshlrev_b32 v26, 5, v0
    v_add_u32 v26, s31, v26
    v_add_u32 v27, s68, v26
    v_add_u32 v26, s63, v26
    s_barrier
    ds_read_b128 v[32:35], v26 offset:0
    ds_read_b128 v[36:39], v26 offset:16
    ds_read_b128 v[40:43], v26 offset:32
    v_lshrrev_b32 v28, 1, v0
    v_mul_u32_u24 v28, 4160, v28
    v_and_b32 v29, 1, v0
    v_lshl_add_u32 v28, v29, 4, v28
    s_add_u32 s31, s68, 4096
    v_add_u32 v28, s31, v28
    v_mov_b32 v72, 0
    v_mov_b32 v73, 0
    v_mov_b32 v74, 0
    v_mov_b32 v75, 0
    s_mov_b64 exec, 63
    ds_write_b128 v28, v[72:75]
    s_mov_b64 exec, -1
    s_waitcnt lgkmcnt(1)
    v_alignbyte_b32 v48, v33, v32, 2
    v_mov_b32 v56, v33
    v_alignbyte_b32 v64, v34, v33, 2
    v_alignbyte_b32 v49, v34, v33, 2
    v_mov_b32 v57, v34
    v_alignbyte_b32 v65, v35, v34, 2
    v_alignbyte_b32 v50, v35, v34, 2
    v_mov_b32 v58, v35
    v_alignbyte_b32 v66, v36, v35, 2
    v_alignbyte_b32 v51, v36, v35, 2
    v_mov_b32 v59, v36
    v_alignbyte_b32 v67, v37, v36, 2
    v_alignbyte_b32 v52, v37, v36, 2
    v_mov_b32 v60, v37
    v_alignbyte_b32 v68, v38, v37, 2
    v_alignbyte_b32 v53, v38, v37, 2
    v_mov_b32 v61, v38
    v_alignbyte_b32 v69, v39, v38, 2
    v_alignbyte_b32 v54, v39, v38, 2
    v_mov_b32 v62, v39
    v_alignbyte_b32 v70, v40, v39, 2
    v_alignbyte_b32 v55, v40, v39, 2
    v_mov_b32 v63, v40
    v_alignbyte_b32 v71, v41, v40, 2
    ds_write_b128 v27, v[48:51] offset:0
    ds_write_b128 v27, v[52:55] offset:16
    ds_write_b128 v27, v[56:59] offset:4160
    ds_write_b128 v27, v[60:63] offset:4176
    ds_write_b128 v27, v[64:67] offset:8320
    ds_write_b128 v27, v[68:71] offset:8336
    s_waitcnt lgkmcnt(0)
    s_barrier
    s_bitcmp1_b32 s62, 0
    s_cselect_b32 s31, 0, 16
    s_lshl_b32 s70, s70, s31
    s_and_b32 s70, s70, 0xffff0000
    s_cmp_eq_u32 s61, 1
    s_cbranch_scc1 L_h1_20
    ds_read_b64 v[32:33], v4 offset:4032
    ds_read_b64 v[34:35], v4 offset:4040
    ds_read_b128 v[64:67], v5 offset:448
    ds_read_b64 v[36:37], v4 offset:3520
    ds_read_b64 v[38:39], v4 offset:3528
    ds_read_b128 v[68:71], v5 offset:960
    ds_read_b64 v[40:41], v4 offset:3008
    ds_read_b64 v[42:43], v4 offset:3016
    ds_read_b128 v[72:75], v5 offset:1472
    ds_read_b64 v[44:45], v4 offset:2496
    ds_read_b64 v[46:47], v4 offset:2504
    ds_read_b128 v[76:79], v5 offset:1984
    ds_read_b64 v[48:49], v4 offset:1984
    ds_read_b64 v[50:51], v4 offset:1992
    ds_read_b128 v[80:83], v5 offset:2496
    ds_read_b64 v[52:53], v4 offset:1472
    ds_read_b64 v[54:55], v4 offset:1480
    ds_read_b128 v[84:87], v5 offset:3008
    ds_read_b64 v[56:57], v4 offset:960
    ds_read_b64 v[58:59], v4 offset:968
    ds_read_b128 v[88:91], v5 offset:3520
    ds_read_b64 v[60:61], v4 offset:448
    ds_read_b64 v[62:63], v4 offset:456
    ds_read_b128 v[92:95], v5 offset:4032
    s_waitcnt lgkmcnt(0)
    v_mfma_f32_16x16x32_bf16 v[8:11], v[32:35], v[64:67], 0
    ds_read_b64 v[96:97], v4 offset:3968
    ds_read_b64 v[98:99], v4 offset:3976
    v_mfma_f32_16x16x32_bf16 v[12:15], v[32:35], v[76:79], 0
    ds_read_b128 v[128:131], v5 offset:384
    ds_read_b64 v[100:101], v4 offset:3456
    v_mfma_f32_16x16x32_bf16 v[12:15], v[36:39], v[72:75], v[12:15]
    ds_read_b64 v[102:103], v4 offset:3464
    ds_read_b128 v[132:135], v5 offset:896
    v_mfma_f32_16x16x32_bf16 v[12:15], v[40:43], v[68:71], v[12:15]
    ds_read_b64 v[104:105], v4 offset:2944
    ds_read_b64 v[106:107], v4 offset:2952
    v_mfma_f32_16x16x32_bf16 v[12:15], v[44:47], v[64:67], v[12:15]
    ds_read_b128 v[136:139], v5 offset:1408
    ds_read_b64 v[108:109], v4 offset:2432
    v_mfma_f32_16x16x32_bf16 v[16:19], v[32:35], v[80:83], 0
    ds_read_b64 v[110:111], v4 offset:2440
    ds_read_b128 v[140:143], v5 offset:1920
    v_mfma_f32_16x16x32_bf16 v[16:19], v[36:39], v[76:79], v[16:19]
    ds_read_b64 v[112:113], v4 offset:1920
    ds_read_b64 v[114:115], v4 offset:1928
    v_mfma_f32_16x16x32_bf16 v[16:19], v[40:43], v[72:75], v[16:19]
    ds_read_b128 v[144:147], v5 offset:2432
    ds_read_b64 v[116:117], v4 offset:1408
    v_mfma_f32_16x16x32_bf16 v[16:19], v[44:47], v[68:71], v[16:19]
    ds_read_b64 v[118:119], v4 offset:1416
    ds_read_b128 v[148:151], v5 offset:2944
    v_mfma_f32_16x16x32_bf16 v[16:19], v[48:51], v[64:67], v[16:19]
    ds_read_b64 v[120:121], v4 offset:896
    ds_read_b64 v[122:123], v4 offset:904
    v_mfma_f32_16x16x32_bf16 v[20:23], v[32:35], v[92:95], 0
    ds_read_b128 v[152:155], v5 offset:3456
    ds_read_b64 v[124:125], v4 offset:384
    v_mfma_f32_16x16x32_bf16 v[20:23], v[36:39], v[88:91], v[20:23]
    ds_read_b64 v[126:127], v4 offset:392
    ds_read_b128 v[156:159], v5 offset:3968
    v_mfma_f32_16x16x32_bf16 v[20:23], v[40:43], v[84:87], v[20:23]
    v_mfma_f32_16x16x32_bf16 v[20:23], v[44:47], v[80:83], v[20:23]
    v_mfma_f32_16x16x32_bf16 v[20:23], v[48:51], v[76:79], v[20:23]
    v_mfma_f32_16x16x32_bf16 v[20:23], v[52:55], v[72:75], v[20:23]
    v_mfma_f32_16x16x32_bf16 v[20:23], v[56:59], v[68:71], v[20:23]
    v_mfma_f32_16x16x32_bf16 v[20:23], v[60:63], v[64:67], v[20:23]
    s_waitcnt lgkmcnt(0)
    v_mfma_f32_16x16x32_bf16 v[8:11], v[96:99], v[128:131], v[8:11]
    ds_read_b64 v[32:33], v4 offset:3904
    ds_read_b64 v[34:35], v4 offset:3912
    v_mfma_f32_16x16x32_bf16 v[12:15], v[96:99], v[140:143], v[12:15]
    ds_read_b128 v[64:67], v5 offset:320
    ds_read_b64 v[36:37], v4 offset:3392
    v_mfma_f32_16x16x32_bf16 v[12:15], v[100:103], v[136:139], v[12:15]
    ds_read_b64 v[38:39], v4 offset:3400
    ds_read_b128 v[68:71], v5 offset:832
    v_mfma_f32_16x16x32_bf16 v[12:15], v[104:107], v[132:135], v[12:15]
    ds_read_b64 v[40:41], v4 offset:2880
    ds_read_b64 v[42:43], v4 offset:2888
    v_mfma_f32_16x16x32_bf16 v[12:15], v[108:111], v[128:131], v[12:15]
    ds_read_b128 v[72:75], v5 offset:1344
    ds_read_b64 v[44:45], v4 offset:2368
    v_mfma_f32_16x16x32_bf16 v[16:19], v[96:99], v[144:147], v[16:19]
    ds_read_b64 v[46:47], v4 offset:2376
    ds_read_b128 v[76:79], v5 offset:1856
    v_mfma_f32_16x16x32_bf16 v[16:19], v[100:103], v[140:143], v[16:19]
    ds_read_b64 v[48:49], v4 offset:1856
    ds_read_b64 v[50:51], v4 offset:1864
    v_mfma_f32_16x16x32_bf16 v[16:19], v[104:107], v[136:139], v[16:19]
    ds_read_b128 v[80:83], v5 offset:2368
    ds_read_b64 v[52:53], v4 offset:1344
    v_mfma_f32_16x16x32_bf16 v[16:19], v[108:111], v[132:135], v[16:19]
    ds_read_b64 v[54:55], v4 offset:1352
    ds_read_b128 v[84:87], v5 offset:2880
    v_mfma_f32_16x16x32_bf16 v[16:19], v[112:115], v[128:131], v[16:19]
    ds_read_b64 v[56:57], v4 offset:832
    ds_read_b64 v[58:59], v4 offset:840
    v_mfma_f32_16x16x32_bf16 v[20:23], v[96:99], v[156:159], v[20:23]
    ds_read_b128 v[88:91], v5 offset:3392
    ds_read_b64 v[60:61], v4 offset:320
    v_mfma_f32_16x16x32_bf16 v[20:23], v[100:103], v[152:155], v[20:23]
    ds_read_b64 v[62:63], v4 offset:328
    ds_read_b128 v[92:95], v5 offset:3904
    v_mfma_f32_16x16x32_bf16 v[20:23], v[104:107], v[148:151], v[20:23]
    v_mfma_f32_16x16x32_bf16 v[20:23], v[108:111], v[144:147], v[20:23]
    v_mfma_f32_16x16x32_bf16 v[20:23], v[112:115], v[140:143], v[20:23]
    v_mfma_f32_16x16x32_bf16 v[20:23], v[116:119], v[136:139], v[20:23]
    v_mfma_f32_16x16x32_bf16 v[20:23], v[120:123], v[132:135], v[20:23]
    v_mfma_f32_16x16x32_bf16 v[20:23], v[124:127], v[128:131], v[20:23]
    s_waitcnt lgkmcnt(0)
    s_waitcnt vmcnt(0)
    s_lshl_b32 s31, s86, 8
    s_lshl_b32 s95, s87, 2
    s_add_u32 s31, s31, s95
    s_add_u32 s31, s31, 31531008
    v_mov_b32 v24, 0
    v_mov_b32 v25, s9
    s_mov_b64 exec, 1
    buffer_store_dword v25, v24, s[12:15], s31 offen sc1
    s_mov_b64 exec, -1
    v_mfma_f32_16x16x32_bf16 v[8:11], v[32:35], v[64:67], v[8:11]
    ds_read_b64 v[96:97], v4 offset:3840
    ds_read_b64 v[98:99], v4 offset:3848
    v_mfma_f32_16x16x32_bf16 v[12:15], v[32:35], v[76:79], v[12:15]
    ds_read_b128 v[128:131], v5 offset:256
    ds_read_b64 v[100:101], v4 offset:3328
    v_mfma_f32_16x16x32_bf16 v[12:15], v[36:39], v[72:75], v[12:15]
    ds_read_b64 v[102:103], v4 offset:3336
    ds_read_b128 v[132:135], v5 offset:768
    v_mfma_f32_16x16x32_bf16 v[12:15], v[40:43], v[68:71], v[12:15]
    ds_read_b64 v[104:105], v4 offset:2816
    ds_read_b64 v[106:107], v4 offset:2824
    v_mfma_f32_16x16x32_bf16 v[12:15], v[44:47], v[64:67], v[12:15]
    ds_read_b128 v[136:139], v5 offset:1280
    ds_read_b64 v[108:109], v4 offset:2304
    v_mfma_f32_16x16x32_bf16 v[16:19], v[32:35], v[80:83], v[16:19]
    ds_read_b64 v[110:111], v4 offset:2312
    ds_read_b128 v[140:143], v5 offset:1792
    v_mfma_f32_16x16x32_bf16 v[16:19], v[36:39], v[76:79], v[16:19]
    ds_read_b64 v[112:113], v4 offset:1792
    ds_read_b64 v[114:115], v4 offset:1800
    v_mfma_f32_16x16x32_bf16 v[16:19], v[40:43], v[72:75], v[16:19]
    ds_read_b128 v[144:147], v5 offset:2304
    ds_read_b64 v[116:117], v4 offset:1280
    v_mfma_f32_16x16x32_bf16 v[16:19], v[44:47], v[68:71], v[16:19]
    ds_read_b64 v[118:119], v4 offset:1288
    ds_read_b128 v[148:151], v5 offset:2816
    v_mfma_f32_16x16x32_bf16 v[16:19], v[48:51], v[64:67], v[16:19]
    ds_read_b64 v[120:121], v4 offset:768
    ds_read_b64 v[122:123], v4 offset:776
    v_mfma_f32_16x16x32_bf16 v[20:23], v[32:35], v[92:95], v[20:23]
    ds_read_b128 v[152:155], v5 offset:3328
    ds_read_b64 v[124:125], v4 offset:256
    v_mfma_f32_16x16x32_bf16 v[20:23], v[36:39], v[88:91], v[20:23]
    ds_read_b64 v[126:127], v4 offset:264
    ds_read_b128 v[156:159], v5 offset:3840
    v_mfma_f32_16x16x32_bf16 v[20:23], v[40:43], v[84:87], v[20:23]
    v_mfma_f32_16x16x32_bf16 v[20:23], v[44:47], v[80:83], v[20:23]
    v_mfma_f32_16x16x32_bf16 v[20:23], v[48:51], v[76:79], v[20:23]
    v_mfma_f32_16x16x32_bf16 v[20:23], v[52:55], v[72:75], v[20:23]
    v_mfma_f32_16x16x32_bf16 v[20:23], v[56:59], v[68:71], v[20:23]
    v_mfma_f32_16x16x32_bf16 v[20:23], v[60:63], v[64:67], v[20:23]
    s_waitcnt lgkmcnt(0)
    v_mfma_f32_16x16x32_bf16 v[8:11], v[96:99], v[128:131], v[8:11]
    ds_read_b64 v[32:33], v4 offset:3776
    ds_read_b64 v[34:35], v4 offset:3784
    v_mfma_f32_16x16x32_bf16 v[12:15], v[96:99], v[140:143], v[12:15]
    ds_read_b128 v[64:67], v5 offset:192
    ds_read_b64 v[36:37], v4 offset:3264
    v_mfma_f32_16x16x32_bf16 v[12:15], v[100:103], v[136:139], v[12:15]
    ds_read_b64 v[38:39], v4 offset:3272
    ds_read_b128 v[68:71], v5 offset:704
    v_mfma_f32_16x16x32_bf16 v[12:15], v[104:107], v[132:135], v[12:15]
    ds_read_b64 v[40:41], v4 offset:2752
    ds_read_b64 v[42:43], v4 offset:2760
    v_mfma_f32_16x16x32_bf16 v[12:15], v[108:111], v[128:131], v[12:15]
    ds_read_b128 v[72:75], v5 offset:1216
    ds_read_b64 v[44:45], v4 offset:2240
    v_mfma_f32_16x16x32_bf16 v[16:19], v[96:99], v[144:147], v[16:19]
    ds_read_b64 v[46:47], v4 offset:2248
    ds_read_b128 v[76:79], v5 offset:1728
    v_mfma_f32_16x16x32_bf16 v[16:19], v[100:103], v[140:143], v[16:19]
    ds_read_b64 v[48:49], v4 offset:1728
    ds_read_b64 v[50:51], v4 offset:1736
    v_mfma_f32_16x16x32_bf16 v[16:19], v[104:107], v[136:139], v[16:19]
    ds_read_b128 v[80:83], v5 offset:2240
    ds_read_b64 v[52:53], v4 offset:1216
    v_mfma_f32_16x16x32_bf16 v[16:19], v[108:111], v[132:135], v[16:19]
    ds_read_b64 v[54:55], v4 offset:1224
    ds_read_b128 v[84:87], v5 offset:2752
    v_mfma_f32_16x16x32_bf16 v[16:19], v[112:115], v[128:131], v[16:19]
    ds_read_b64 v[56:57], v4 offset:704
    ds_read_b64 v[58:59], v4 offset:712
    v_mfma_f32_16x16x32_bf16 v[20:23], v[96:99], v[156:159], v[20:23]
    ds_read_b128 v[88:91], v5 offset:3264
    ds_read_b64 v[60:61], v4 offset:192
    v_mfma_f32_16x16x32_bf16 v[20:23], v[100:103], v[152:155], v[20:23]
    ds_read_b64 v[62:63], v4 offset:200
    ds_read_b128 v[92:95], v5 offset:3776
    v_mfma_f32_16x16x32_bf16 v[20:23], v[104:107], v[148:151], v[20:23]
    v_mfma_f32_16x16x32_bf16 v[20:23], v[108:111], v[144:147], v[20:23]
    v_mfma_f32_16x16x32_bf16 v[20:23], v[112:115], v[140:143], v[20:23]
    v_mfma_f32_16x16x32_bf16 v[20:23], v[116:119], v[136:139], v[20:23]
    v_mfma_f32_16x16x32_bf16 v[20:23], v[120:123], v[132:135], v[20:23]
    v_mfma_f32_16x16x32_bf16 v[20:23], v[124:127], v[128:131], v[20:23]
    s_waitcnt lgkmcnt(0)
    v_mfma_f32_16x16x32_bf16 v[8:11], v[32:35], v[64:67], v[8:11]
    ds_read_b64 v[96:97], v4 offset:3712
    ds_read_b64 v[98:99], v4 offset:3720
    v_mfma_f32_16x16x32_bf16 v[12:15], v[32:35], v[76:79], v[12:15]
    ds_read_b128 v[128:131], v5 offset:128
    ds_read_b64 v[100:101], v4 offset:3200
    v_mfma_f32_16x16x32_bf16 v[12:15], v[36:39], v[72:75], v[12:15]
    ds_read_b64 v[102:103], v4 offset:3208
    ds_read_b128 v[132:135], v5 offset:640
    v_mfma_f32_16x16x32_bf16 v[12:15], v[40:43], v[68:71], v[12:15]
    ds_read_b64 v[104:105], v4 offset:2688
    ds_read_b64 v[106:107], v4 offset:2696
    v_mfma_f32_16x16x32_bf16 v[12:15], v[44:47], v[64:67], v[12:15]
    ds_read_b128 v[136:139], v5 offset:1152
    ds_read_b64 v[108:109], v4 offset:2176
    v_mfma_f32_16x16x32_bf16 v[16:19], v[32:35], v[80:83], v[16:19]
    ds_read_b64 v[110:111], v4 offset:2184
    ds_read_b128 v[140:143], v5 offset:1664
    v_mfma_f32_16x16x32_bf16 v[16:19], v[36:39], v[76:79], v[16:19]
    ds_read_b64 v[112:113], v4 offset:1664
    ds_read_b64 v[114:115], v4 offset:1672
    v_mfma_f32_16x16x32_bf16 v[16:19], v[40:43], v[72:75], v[16:19]
    ds_read_b128 v[144:147], v5 offset:2176
    ds_read_b64 v[116:117], v4 offset:1152
    v_mfma_f32_16x16x32_bf16 v[16:19], v[44:47], v[68:71], v[16:19]
    ds_read_b64 v[118:119], v4 offset:1160
    ds_read_b128 v[148:151], v5 offset:2688
    v_mfma_f32_16x16x32_bf16 v[16:19], v[48:51], v[64:67], v[16:19]
    ds_read_b64 v[120:121], v4 offset:640
    ds_read_b64 v[122:123], v4 offset:648
    v_mfma_f32_16x16x32_bf16 v[20:23], v[32:35], v[92:95], v[20:23]
    ds_read_b128 v[152:155], v5 offset:3200
    ds_read_b64 v[124:125], v4 offset:128
    v_mfma_f32_16x16x32_bf16 v[20:23], v[36:39], v[88:91], v[20:23]
    ds_read_b64 v[126:127], v4 offset:136
    ds_read_b128 v[156:159], v5 offset:3712
    v_mfma_f32_16x16x32_bf16 v[20:23], v[40:43], v[84:87], v[20:23]
    v_mfma_f32_16x16x32_bf16 v[20:23], v[44:47], v[80:83], v[20:23]
    v_mfma_f32_16x16x32_bf16 v[20:23], v[48:51], v[76:79], v[20:23]
    v_mfma_f32_16x16x32_bf16 v[20:23], v[52:55], v[72:75], v[20:23]
    v_mfma_f32_16x16x32_bf16 v[20:23], v[56:59], v[68:71], v[20:23]
    v_mfma_f32_16x16x32_bf16 v[20:23], v[60:63], v[64:67], v[20:23]
    s_waitcnt lgkmcnt(0)
    v_mfma_f32_16x16x32_bf16 v[8:11], v[96:99], v[128:131], v[8:11]
    ds_read_b64 v[32:33], v4 offset:3648
    ds_read_b64 v[34:35], v4 offset:3656
    v_mfma_f32_16x16x32_bf16 v[12:15], v[96:99], v[140:143], v[12:15]
    ds_read_b128 v[64:67], v5 offset:64
    ds_read_b64 v[36:37], v4 offset:3136
    v_mfma_f32_16x16x32_bf16 v[12:15], v[100:103], v[136:139], v[12:15]
    ds_read_b64 v[38:39], v4 offset:3144
    ds_read_b128 v[68:71], v5 offset:576
    v_mfma_f32_16x16x32_bf16 v[12:15], v[104:107], v[132:135], v[12:15]
    ds_read_b64 v[40:41], v4 offset:2624
    ds_read_b64 v[42:43], v4 offset:2632
    v_mfma_f32_16x16x32_bf16 v[12:15], v[108:111], v[128:131], v[12:15]
    ds_read_b128 v[72:75], v5 offset:1088
    ds_read_b64 v[44:45], v4 offset:2112
    v_mfma_f32_16x16x32_bf16 v[16:19], v[96:99], v[144:147], v[16:19]
    ds_read_b64 v[46:47], v4 offset:2120
    ds_read_b128 v[76:79], v5 offset:1600
    v_mfma_f32_16x16x32_bf16 v[16:19], v[100:103], v[140:143], v[16:19]
    ds_read_b64 v[48:49], v4 offset:1600
    ds_read_b64 v[50:51], v4 offset:1608
    v_mfma_f32_16x16x32_bf16 v[16:19], v[104:107], v[136:139], v[16:19]
    ds_read_b128 v[80:83], v5 offset:2112
    ds_read_b64 v[52:53], v4 offset:1088
    v_mfma_f32_16x16x32_bf16 v[16:19], v[108:111], v[132:135], v[16:19]
    ds_read_b64 v[54:55], v4 offset:1096
    ds_read_b128 v[84:87], v5 offset:2624
    v_mfma_f32_16x16x32_bf16 v[16:19], v[112:115], v[128:131], v[16:19]
    ds_read_b64 v[56:57], v4 offset:576
    ds_read_b64 v[58:59], v4 offset:584
    v_mfma_f32_16x16x32_bf16 v[20:23], v[96:99], v[156:159], v[20:23]
    ds_read_b128 v[88:91], v5 offset:3136
    ds_read_b64 v[60:61], v4 offset:64
    v_mfma_f32_16x16x32_bf16 v[20:23], v[100:103], v[152:155], v[20:23]
    ds_read_b64 v[62:63], v4 offset:72
    ds_read_b128 v[92:95], v5 offset:3648
    v_mfma_f32_16x16x32_bf16 v[20:23], v[104:107], v[148:151], v[20:23]
    v_mfma_f32_16x16x32_bf16 v[20:23], v[108:111], v[144:147], v[20:23]
    v_mfma_f32_16x16x32_bf16 v[20:23], v[112:115], v[140:143], v[20:23]
    v_mfma_f32_16x16x32_bf16 v[20:23], v[116:119], v[136:139], v[20:23]
    v_mfma_f32_16x16x32_bf16 v[20:23], v[120:123], v[132:135], v[20:23]
    v_mfma_f32_16x16x32_bf16 v[20:23], v[124:127], v[128:131], v[20:23]
    s_waitcnt lgkmcnt(0)
    v_mfma_f32_16x16x32_bf16 v[8:11], v[32:35], v[64:67], v[8:11]
    ds_read_b64 v[96:97], v4 offset:3584
    ds_read_b64 v[98:99], v4 offset:3592
    v_mfma_f32_16x16x32_bf16 v[12:15], v[32:35], v[76:79], v[12:15]
    ds_read_b128 v[128:131], v5 offset:0
    ds_read_b64 v[100:101], v4 offset:3072
    v_mfma_f32_16x16x32_bf16 v[12:15], v[36:39], v[72:75], v[12:15]
    ds_read_b64 v[102:103], v4 offset:3080
    ds_read_b128 v[132:135], v5 offset:512
    v_mfma_f32_16x16x32_bf16 v[12:15], v[40:43], v[68:71], v[12:15]
    ds_read_b64 v[104:105], v4 offset:2560
    ds_read_b64 v[106:107], v4 offset:2568
    v_mfma_f32_16x16x32_bf16 v[12:15], v[44:47], v[64:67], v[12:15]
    ds_read_b128 v[136:139], v5 offset:1024
    ds_read_b64 v[108:109], v4 offset:2048
    v_mfma_f32_16x16x32_bf16 v[16:19], v[32:35], v[80:83], v[16:19]
    ds_read_b64 v[110:111], v4 offset:2056
    ds_read_b128 v[140:143], v5 offset:1536
    v_mfma_f32_16x16x32_bf16 v[16:19], v[36:39], v[76:79], v[16:19]
    ds_read_b64 v[112:113], v4 offset:1536
    ds_read_b64 v[114:115], v4 offset:1544
    v_mfma_f32_16x16x32_bf16 v[16:19], v[40:43], v[72:75], v[16:19]
    ds_read_b128 v[144:147], v5 offset:2048
    ds_read_b64 v[116:117], v4 offset:1024
    v_mfma_f32_16x16x32_bf16 v[16:19], v[44:47], v[68:71], v[16:19]
    ds_read_b64 v[118:119], v4 offset:1032
    ds_read_b128 v[148:151], v5 offset:2560
    v_mfma_f32_16x16x32_bf16 v[16:19], v[48:51], v[64:67], v[16:19]
    ds_read_b64 v[120:121], v4 offset:512
    ds_read_b64 v[122:123], v4 offset:520
    v_mfma_f32_16x16x32_bf16 v[20:23], v[32:35], v[92:95], v[20:23]
    ds_read_b128 v[152:155], v5 offset:3072
    ds_read_b64 v[124:125], v4 offset:0
    v_mfma_f32_16x16x32_bf16 v[20:23], v[36:39], v[88:91], v[20:23]
    ds_read_b64 v[126:127], v4 offset:8
    ds_read_b128 v[156:159], v5 offset:3584
    v_mfma_f32_16x16x32_bf16 v[20:23], v[40:43], v[84:87], v[20:23]
    v_mfma_f32_16x16x32_bf16 v[20:23], v[44:47], v[80:83], v[20:23]
    v_mfma_f32_16x16x32_bf16 v[20:23], v[48:51], v[76:79], v[20:23]
    v_mfma_f32_16x16x32_bf16 v[20:23], v[52:55], v[72:75], v[20:23]
    v_mfma_f32_16x16x32_bf16 v[20:23], v[56:59], v[68:71], v[20:23]
    v_mfma_f32_16x16x32_bf16 v[20:23], v[60:63], v[64:67], v[20:23]
    s_waitcnt lgkmcnt(0)
    v_mfma_f32_16x16x32_bf16 v[8:11], v[96:99], v[128:131], v[8:11]
    v_mfma_f32_16x16x32_bf16 v[12:15], v[96:99], v[140:143], v[12:15]
    v_mfma_f32_16x16x32_bf16 v[12:15], v[100:103], v[136:139], v[12:15]
    v_mfma_f32_16x16x32_bf16 v[12:15], v[104:107], v[132:135], v[12:15]
    v_mfma_f32_16x16x32_bf16 v[12:15], v[108:111], v[128:131], v[12:15]
    v_mfma_f32_16x16x32_bf16 v[16:19], v[96:99], v[144:147], v[16:19]
    v_mfma_f32_16x16x32_bf16 v[16:19], v[100:103], v[140:143], v[16:19]
    v_mfma_f32_16x16x32_bf16 v[16:19], v[104:107], v[136:139], v[16:19]
    v_mfma_f32_16x16x32_bf16 v[16:19], v[108:111], v[132:135], v[16:19]
    v_mfma_f32_16x16x32_bf16 v[16:19], v[112:115], v[128:131], v[16:19]
    v_mfma_f32_16x16x32_bf16 v[20:23], v[96:99], v[156:159], v[20:23]
    v_mfma_f32_16x16x32_bf16 v[20:23], v[100:103], v[152:155], v[20:23]
    v_mfma_f32_16x16x32_bf16 v[20:23], v[104:107], v[148:151], v[20:23]
    v_mfma_f32_16x16x32_bf16 v[20:23], v[108:111], v[144:147], v[20:23]
    v_mfma_f32_16x16x32_bf16 v[20:23], v[112:115], v[140:143], v[20:23]
    v_mfma_f32_16x16x32_bf16 v[20:23], v[116:119], v[136:139], v[20:23]
    v_mfma_f32_16x16x32_bf16 v[20:23], v[120:123], v[132:135], v[20:23]
    v_mfma_f32_16x16x32_bf16 v[20:23], v[124:127], v[128:131], v[20:23]
    ds_read_b64 v[32:33], v7 offset:3584
    ds_read_b64 v[34:35], v7 offset:2048
    ds_read_b64 v[36:37], v7 offset:1536
    ds_read_b64 v[38:39], v7 offset:0
    s_waitcnt lgkmcnt(0)
    s_nop 7
    v_and_b32 v48, 0xffff0000, v33
    v_lshlrev_b32 v49, 16, v33
    v_and_b32 v50, 0xffff0000, v32
    v_lshlrev_b32 v51, 16, v32
    v_fma_f32 v8, v48, s70, v8
    v_fma_f32 v9, v49, s70, v9
    v_fma_f32 v10, v50, s70, v10
    v_fma_f32 v11, v51, s70, v11
    v_cvt_pk_bf16_f32 v56, v8, v9
    v_cvt_pk_bf16_f32 v57, v10, v11
    buffer_store_dwordx2 v[56:57], v6, s[12:15], s64 offen offset:0 sc1
    v_and_b32 v48, 0xffff0000, v35
    v_lshlrev_b32 v49, 16, v35
    v_and_b32 v50, 0xffff0000, v34
    v_lshlrev_b32 v51, 16, v34
    v_fma_f32 v12, v48, s70, v12
    v_fma_f32 v13, v49, s70, v13
    v_fma_f32 v14, v50, s70, v14
    v_fma_f32 v15, v51, s70, v15
    v_cvt_pk_bf16_f32 v58, v12, v13
    v_cvt_pk_bf16_f32 v59, v14, v15
    buffer_store_dwordx2 v[58:59], v6, s[12:15], s64 offen offset:1536 sc1
    v_and_b32 v48, 0xffff0000, v37
    v_lshlrev_b32 v49, 16, v37
    v_and_b32 v50, 0xffff0000, v36
    v_lshlrev_b32 v51, 16, v36
    v_fma_f32 v16, v48, s70, v16
    v_fma_f32 v17, v49, s70, v17
    v_fma_f32 v18, v50, s70, v18
    v_fma_f32 v19, v51, s70, v19
    v_cvt_pk_bf16_f32 v60, v16, v17
    v_cvt_pk_bf16_f32 v61, v18, v19
    buffer_store_dwordx2 v[60:61], v6, s[12:15], s64 offen offset:2048 sc1
    v_and_b32 v48, 0xffff0000, v39
    v_lshlrev_b32 v49, 16, v39
    v_and_b32 v50, 0xffff0000, v38
    v_lshlrev_b32 v51, 16, v38
    v_fma_f32 v20, v48, s70, v20
    v_fma_f32 v21, v49, s70, v21
    v_fma_f32 v22, v50, s70, v22
    v_fma_f32 v23, v51, s70, v23
    v_cvt_pk_bf16_f32 v62, v20, v21
    v_cvt_pk_bf16_f32 v63, v22, v23
    buffer_store_dwordx2 v[62:63], v6, s[12:15], s64 offen offset:3584 sc1
    s_branch L_cdone_21
L_h1_20:
    ds_read_b64 v[32:33], v4 offset:4032
    ds_read_b64 v[34:35], v4 offset:4040
    ds_read_b128 v[64:67], v5 offset:448
    ds_read_b64 v[36:37], v4 offset:3520
    ds_read_b64 v[38:39], v4 offset:3528
    ds_read_b128 v[68:71], v5 offset:960
    ds_read_b64 v[40:41], v4 offset:3008
    ds_read_b64 v[42:43], v4 offset:3016
    ds_read_b128 v[72:75], v5 offset:1472
    ds_read_b64 v[44:45], v4 offset:2496
    ds_read_b64 v[46:47], v4 offset:2504
    ds_read_b128 v[76:79], v5 offset:1984
    ds_read_b64 v[48:49], v4 offset:1984
    ds_read_b64 v[50:51], v4 offset:1992
    ds_read_b128 v[80:83], v5 offset:2496
    ds_read_b64 v[52:53], v4 offset:1472
    ds_read_b64 v[54:55], v4 offset:1480
    ds_read_b128 v[84:87], v5 offset:3008
    ds_read_b64 v[56:57], v4 offset:960
    ds_read_b64 v[58:59], v4 offset:968
    ds_read_b128 v[88:91], v5 offset:3520
    s_waitcnt lgkmcnt(0)
    v_mfma_f32_16x16x32_bf16 v[8:11], v[32:35], v[68:71], 0
    ds_read_b64 v[96:97], v4 offset:3968
    ds_read_b64 v[98:99], v4 offset:3976
    v_mfma_f32_16x16x32_bf16 v[8:11], v[36:39], v[64:67], v[8:11]
    ds_read_b128 v[128:131], v5 offset:384
    ds_read_b64 v[100:101], v4 offset:3456
    v_mfma_f32_16x16x32_bf16 v[12:15], v[32:35], v[72:75], 0
    ds_read_b64 v[102:103], v4 offset:3464
    ds_read_b128 v[132:135], v5 offset:896
    v_mfma_f32_16x16x32_bf16 v[12:15], v[36:39], v[68:71], v[12:15]
    ds_read_b64 v[104:105], v4 offset:2944
    ds_read_b64 v[106:107], v4 offset:2952
    v_mfma_f32_16x16x32_bf16 v[12:15], v[40:43], v[64:67], v[12:15]
    ds_read_b128 v[136:139], v5 offset:1408
    ds_read_b64 v[108:109], v4 offset:2432
    v_mfma_f32_16x16x32_bf16 v[16:19], v[32:35], v[84:87], 0
    ds_read_b64 v[110:111], v4 offset:2440
    ds_read_b128 v[140:143], v5 offset:1920
    v_mfma_f32_16x16x32_bf16 v[16:19], v[36:39], v[80:83], v[16:19]
    ds_read_b64 v[112:113], v4 offset:1920
    ds_read_b64 v[114:115], v4 offset:1928
    v_mfma_f32_16x16x32_bf16 v[16:19], v[40:43], v[76:79], v[16:19]
    ds_read_b128 v[144:147], v5 offset:2432
    ds_read_b64 v[116:117], v4 offset:1408
    v_mfma_f32_16x16x32_bf16 v[16:19], v[44:47], v[72:75], v[16:19]
    ds_read_b64 v[118:119], v4 offset:1416
    ds_read_b128 v[148:151], v5 offset:2944
    v_mfma_f32_16x16x32_bf16 v[16:19], v[48:51], v[68:71], v[16:19]
    ds_read_b64 v[120:121], v4 offset:896
    ds_read_b64 v[122:123], v4 offset:904
    v_mfma_f32_16x16x32_bf16 v[16:19], v[52:55], v[64:67], v[16:19]
    ds_read_b128 v[152:155], v5 offset:3456
    v_mfma_f32_16x16x32_bf16 v[20:23], v[32:35], v[88:91], 0
    v_mfma_f32_16x16x32_bf16 v[20:23], v[36:39], v[84:87], v[20:23]
    v_mfma_f32_16x16x32_bf16 v[20:23], v[40:43], v[80:83], v[20:23]
    v_mfma_f32_16x16x32_bf16 v[20:23], v[44:47], v[76:79], v[20:23]
    v_mfma_f32_16x16x32_bf16 v[20:23], v[48:51], v[72:75], v[20:23]
    v_mfma_f32_16x16x32_bf16 v[20:23], v[52:55], v[68:71], v[20:23]
    v_mfma_f32_16x16x32_bf16 v[20:23], v[56:59], v[64:67], v[20:23]
    s_waitcnt lgkmcnt(0)
    v_mfma_f32_16x16x32_bf16 v[8:11], v[96:99], v[132:135], v[8:11]
    ds_read_b64 v[32:33], v4 offset:3904
    ds_read_b64 v[34:35], v4 offset:3912
    v_mfma_f32_16x16x32_bf16 v[8:11], v[100:103], v[128:131], v[8:11]
    ds_read_b128 v[64:67], v5 offset:320
    ds_read_b64 v[36:37], v4 offset:3392
    v_mfma_f32_16x16x32_bf16 v[12:15], v[96:99], v[136:139], v[12:15]
    ds_read_b64 v[38:39], v4 offset:3400
    ds_read_b128 v[68:71], v5 offset:832
    v_mfma_f32_16x16x32_bf16 v[12:15], v[100:103], v[132:135], v[12:15]
    ds_read_b64 v[40:41], v4 offset:2880
    ds_read_b64 v[42:43], v4 offset:2888
    v_mfma_f32_16x16x32_bf16 v[12:15], v[104:107], v[128:131], v[12:15]
    ds_read_b128 v[72:75], v5 offset:1344
    ds_read_b64 v[44:45], v4 offset:2368
    v_mfma_f32_16x16x32_bf16 v[16:19], v[96:99], v[148:151], v[16:19]
    ds_read_b64 v[46:47], v4 offset:2376
    ds_read_b128 v[76:79], v5 offset:1856
    v_mfma_f32_16x16x32_bf16 v[16:19], v[100:103], v[144:147], v[16:19]
    ds_read_b64 v[48:49], v4 offset:1856
    ds_read_b64 v[50:51], v4 offset:1864
    v_mfma_f32_16x16x32_bf16 v[16:19], v[104:107], v[140:143], v[16:19]
    ds_read_b128 v[80:83], v5 offset:2368
    ds_read_b64 v[52:53], v4 offset:1344
    v_mfma_f32_16x16x32_bf16 v[16:19], v[108:111], v[136:139], v[16:19]
    ds_read_b64 v[54:55], v4 offset:1352
    ds_read_b128 v[84:87], v5 offset:2880
    v_mfma_f32_16x16x32_bf16 v[16:19], v[112:115], v[132:135], v[16:19]
    ds_read_b64 v[56:57], v4 offset:832
    ds_read_b64 v[58:59], v4 offset:840
    v_mfma_f32_16x16x32_bf16 v[16:19], v[116:119], v[128:131], v[16:19]
    ds_read_b128 v[88:91], v5 offset:3392
    v_mfma_f32_16x16x32_bf16 v[20:23], v[96:99], v[152:155], v[20:23]
    v_mfma_f32_16x16x32_bf16 v[20:23], v[100:103], v[148:151], v[20:23]
    v_mfma_f32_16x16x32_bf16 v[20:23], v[104:107], v[144:147], v[20:23]
    v_mfma_f32_16x16x32_bf16 v[20:23], v[108:111], v[140:143], v[20:23]
    v_mfma_f32_16x16x32_bf16 v[20:23], v[112:115], v[136:139], v[20:23]
    v_mfma_f32_16x16x32_bf16 v[20:23], v[116:119], v[132:135], v[20:23]
    v_mfma_f32_16x16x32_bf16 v[20:23], v[120:123], v[128:131], v[20:23]
    s_waitcnt lgkmcnt(0)
    v_mfma_f32_16x16x32_bf16 v[8:11], v[32:35], v[68:71], v[8:11]
    ds_read_b64 v[96:97], v4 offset:3840
    ds_read_b64 v[98:99], v4 offset:3848
    v_mfma_f32_16x16x32_bf16 v[8:11], v[36:39], v[64:67], v[8:11]
    ds_read_b128 v[128:131], v5 offset:256
    ds_read_b64 v[100:101], v4 offset:3328
    v_mfma_f32_16x16x32_bf16 v[12:15], v[32:35], v[72:75], v[12:15]
    ds_read_b64 v[102:103], v4 offset:3336
    ds_read_b128 v[132:135], v5 offset:768
    v_mfma_f32_16x16x32_bf16 v[12:15], v[36:39], v[68:71], v[12:15]
    ds_read_b64 v[104:105], v4 offset:2816
    ds_read_b64 v[106:107], v4 offset:2824
    v_mfma_f32_16x16x32_bf16 v[12:15], v[40:43], v[64:67], v[12:15]
    ds_read_b128 v[136:139], v5 offset:1280
    ds_read_b64 v[108:109], v4 offset:2304
    v_mfma_f32_16x16x32_bf16 v[16:19], v[32:35], v[84:87], v[16:19]
    ds_read_b64 v[110:111], v4 offset:2312
    ds_read_b128 v[140:143], v5 offset:1792
    v_mfma_f32_16x16x32_bf16 v[16:19], v[36:39], v[80:83], v[16:19]
    ds_read_b64 v[112:113], v4 offset:1792
    ds_read_b64 v[114:115], v4 offset:1800
    v_mfma_f32_16x16x32_bf16 v[16:19], v[40:43], v[76:79], v[16:19]
    ds_read_b128 v[144:147], v5 offset:2304
    ds_read_b64 v[116:117], v4 offset:1280
    v_mfma_f32_16x16x32_bf16 v[16:19], v[44:47], v[72:75], v[16:19]
    ds_read_b64 v[118:119], v4 offset:1288
    ds_read_b128 v[148:151], v5 offset:2816
    v_mfma_f32_16x16x32_bf16 v[16:19], v[48:51], v[68:71], v[16:19]
    ds_read_b64 v[120:121], v4 offset:768
    ds_read_b64 v[122:123], v4 offset:776
    v_mfma_f32_16x16x32_bf16 v[16:19], v[52:55], v[64:67], v[16:19]
    ds_read_b128 v[152:155], v5 offset:3328
    v_mfma_f32_16x16x32_bf16 v[20:23], v[32:35], v[88:91], v[20:23]
    v_mfma_f32_16x16x32_bf16 v[20:23], v[36:39], v[84:87], v[20:23]
    v_mfma_f32_16x16x32_bf16 v[20:23], v[40:43], v[80:83], v[20:23]
    v_mfma_f32_16x16x32_bf16 v[20:23], v[44:47], v[76:79], v[20:23]
    v_mfma_f32_16x16x32_bf16 v[20:23], v[48:51], v[72:75], v[20:23]
    v_mfma_f32_16x16x32_bf16 v[20:23], v[52:55], v[68:71], v[20:23]
    v_mfma_f32_16x16x32_bf16 v[20:23], v[56:59], v[64:67], v[20:23]
    s_waitcnt lgkmcnt(0)
    v_mfma_f32_16x16x32_bf16 v[8:11], v[96:99], v[132:135], v[8:11]
    ds_read_b64 v[32:33], v4 offset:3776
    ds_read_b64 v[34:35], v4 offset:3784
    v_mfma_f32_16x16x32_bf16 v[8:11], v[100:103], v[128:131], v[8:11]
    ds_read_b128 v[64:67], v5 offset:192
    ds_read_b64 v[36:37], v4 offset:3264
    v_mfma_f32_16x16x32_bf16 v[12:15], v[96:99], v[136:139], v[12:15]
    ds_read_b64 v[38:39], v4 offset:3272
    ds_read_b128 v[68:71], v5 offset:704
    v_mfma_f32_16x16x32_bf16 v[12:15], v[100:103], v[132:135], v[12:15]
    ds_read_b64 v[40:41], v4 offset:2752
    ds_read_b64 v[42:43], v4 offset:2760
    v_mfma_f32_16x16x32_bf16 v[12:15], v[104:107], v[128:131], v[12:15]
    ds_read_b128 v[72:75], v5 offset:1216
    ds_read_b64 v[44:45], v4 offset:2240
    v_mfma_f32_16x16x32_bf16 v[16:19], v[96:99], v[148:151], v[16:19]
    ds_read_b64 v[46:47], v4 offset:2248
    ds_read_b128 v[76:79], v5 offset:1728
    v_mfma_f32_16x16x32_bf16 v[16:19], v[100:103], v[144:147], v[16:19]
    ds_read_b64 v[48:49], v4 offset:1728
    ds_read_b64 v[50:51], v4 offset:1736
    v_mfma_f32_16x16x32_bf16 v[16:19], v[104:107], v[140:143], v[16:19]
    ds_read_b128 v[80:83], v5 offset:2240
    ds_read_b64 v[52:53], v4 offset:1216
    v_mfma_f32_16x16x32_bf16 v[16:19], v[108:111], v[136:139], v[16:19]
    ds_read_b64 v[54:55], v4 offset:1224
    ds_read_b128 v[84:87], v5 offset:2752
    v_mfma_f32_16x16x32_bf16 v[16:19], v[112:115], v[132:135], v[16:19]
    ds_read_b64 v[56:57], v4 offset:704
    ds_read_b64 v[58:59], v4 offset:712
    v_mfma_f32_16x16x32_bf16 v[16:19], v[116:119], v[128:131], v[16:19]
    ds_read_b128 v[88:91], v5 offset:3264
    v_mfma_f32_16x16x32_bf16 v[20:23], v[96:99], v[152:155], v[20:23]
    v_mfma_f32_16x16x32_bf16 v[20:23], v[100:103], v[148:151], v[20:23]
    v_mfma_f32_16x16x32_bf16 v[20:23], v[104:107], v[144:147], v[20:23]
    v_mfma_f32_16x16x32_bf16 v[20:23], v[108:111], v[140:143], v[20:23]
    v_mfma_f32_16x16x32_bf16 v[20:23], v[112:115], v[136:139], v[20:23]
    v_mfma_f32_16x16x32_bf16 v[20:23], v[116:119], v[132:135], v[20:23]
    v_mfma_f32_16x16x32_bf16 v[20:23], v[120:123], v[128:131], v[20:23]
    s_waitcnt lgkmcnt(0)
    v_mfma_f32_16x16x32_bf16 v[8:11], v[32:35], v[68:71], v[8:11]
    ds_read_b64 v[96:97], v4 offset:3712
    ds_read_b64 v[98:99], v4 offset:3720
    v_mfma_f32_16x16x32_bf16 v[8:11], v[36:39], v[64:67], v[8:11]
    ds_read_b128 v[128:131], v5 offset:128
    ds_read_b64 v[100:101], v4 offset:3200
    v_mfma_f32_16x16x32_bf16 v[12:15], v[32:35], v[72:75], v[12:15]
    ds_read_b64 v[102:103], v4 offset:3208
    ds_read_b128 v[132:135], v5 offset:640
    v_mfma_f32_16x16x32_bf16 v[12:15], v[36:39], v[68:71], v[12:15]
    ds_read_b64 v[104:105], v4 offset:2688
    ds_read_b64 v[106:107], v4 offset:2696
    v_mfma_f32_16x16x32_bf16 v[12:15], v[40:43], v[64:67], v[12:15]
    ds_read_b128 v[136:139], v5 offset:1152
    ds_read_b64 v[108:109], v4 offset:2176
    v_mfma_f32_16x16x32_bf16 v[16:19], v[32:35], v[84:87], v[16:19]
    ds_read_b64 v[110:111], v4 offset:2184
    ds_read_b128 v[140:143], v5 offset:1664
    v_mfma_f32_16x16x32_bf16 v[16:19], v[36:39], v[80:83], v[16:19]
    ds_read_b64 v[112:113], v4 offset:1664
    ds_read_b64 v[114:115], v4 offset:1672
    v_mfma_f32_16x16x32_bf16 v[16:19], v[40:43], v[76:79], v[16:19]
    ds_read_b128 v[144:147], v5 offset:2176
    ds_read_b64 v[116:117], v4 offset:1152
    v_mfma_f32_16x16x32_bf16 v[16:19], v[44:47], v[72:75], v[16:19]
    ds_read_b64 v[118:119], v4 offset:1160
    ds_read_b128 v[148:151], v5 offset:2688
    v_mfma_f32_16x16x32_bf16 v[16:19], v[48:51], v[68:71], v[16:19]
    ds_read_b64 v[120:121], v4 offset:640
    ds_read_b64 v[122:123], v4 offset:648
    v_mfma_f32_16x16x32_bf16 v[16:19], v[52:55], v[64:67], v[16:19]
    ds_read_b128 v[152:155], v5 offset:3200
    v_mfma_f32_16x16x32_bf16 v[20:23], v[32:35], v[88:91], v[20:23]
    v_mfma_f32_16x16x32_bf16 v[20:23], v[36:39], v[84:87], v[20:23]
    v_mfma_f32_16x16x32_bf16 v[20:23], v[40:43], v[80:83], v[20:23]
    v_mfma_f32_16x16x32_bf16 v[20:23], v[44:47], v[76:79], v[20:23]
    v_mfma_f32_16x16x32_bf16 v[20:23], v[48:51], v[72:75], v[20:23]
    v_mfma_f32_16x16x32_bf16 v[20:23], v[52:55], v[68:71], v[20:23]
    v_mfma_f32_16x16x32_bf16 v[20:23], v[56:59], v[64:67], v[20:23]
    s_waitcnt lgkmcnt(0)
    v_mfma_f32_16x16x32_bf16 v[8:11], v[96:99], v[132:135], v[8:11]
    ds_read_b64 v[32:33], v4 offset:3648
    ds_read_b64 v[34:35], v4 offset:3656
    v_mfma_f32_16x16x32_bf16 v[8:11], v[100:103], v[128:131], v[8:11]
    ds_read_b128 v[64:67], v5 offset:64
    ds_read_b64 v[36:37], v4 offset:3136
    v_mfma_f32_16x16x32_bf16 v[12:15], v[96:99], v[136:139], v[12:15]
    ds_read_b64 v[38:39], v4 offset:3144
    ds_read_b128 v[68:71], v5 offset:576
    v_mfma_f32_16x16x32_bf16 v[12:15], v[100:103], v[132:135], v[12:15]
    ds_read_b64 v[40:41], v4 offset:2624
    ds_read_b64 v[42:43], v4 offset:2632
    v_mfma_f32_16x16x32_bf16 v[12:15], v[104:107], v[128:131], v[12:15]
    ds_read_b128 v[72:75], v5 offset:1088
    ds_read_b64 v[44:45], v4 offset:2112
    v_mfma_f32_16x16x32_bf16 v[16:19], v[96:99], v[148:151], v[16:19]
    ds_read_b64 v[46:47], v4 offset:2120
    ds_read_b128 v[76:79], v5 offset:1600
    v_mfma_f32_16x16x32_bf16 v[16:19], v[100:103], v[144:147], v[16:19]
    ds_read_b64 v[48:49], v4 offset:1600
    ds_read_b64 v[50:51], v4 offset:1608
    v_mfma_f32_16x16x32_bf16 v[16:19], v[104:107], v[140:143], v[16:19]
    ds_read_b128 v[80:83], v5 offset:2112
    ds_read_b64 v[52:53], v4 offset:1088
    v_mfma_f32_16x16x32_bf16 v[16:19], v[108:111], v[136:139], v[16:19]
    ds_read_b64 v[54:55], v4 offset:1096
    ds_read_b128 v[84:87], v5 offset:2624
    v_mfma_f32_16x16x32_bf16 v[16:19], v[112:115], v[132:135], v[16:19]
    ds_read_b64 v[56:57], v4 offset:576
    ds_read_b64 v[58:59], v4 offset:584
    v_mfma_f32_16x16x32_bf16 v[16:19], v[116:119], v[128:131], v[16:19]
    ds_read_b128 v[88:91], v5 offset:3136
    v_mfma_f32_16x16x32_bf16 v[20:23], v[96:99], v[152:155], v[20:23]
    v_mfma_f32_16x16x32_bf16 v[20:23], v[100:103], v[148:151], v[20:23]
    v_mfma_f32_16x16x32_bf16 v[20:23], v[104:107], v[144:147], v[20:23]
    v_mfma_f32_16x16x32_bf16 v[20:23], v[108:111], v[140:143], v[20:23]
    v_mfma_f32_16x16x32_bf16 v[20:23], v[112:115], v[136:139], v[20:23]
    v_mfma_f32_16x16x32_bf16 v[20:23], v[116:119], v[132:135], v[20:23]
    v_mfma_f32_16x16x32_bf16 v[20:23], v[120:123], v[128:131], v[20:23]
    s_waitcnt lgkmcnt(0)
    v_mfma_f32_16x16x32_bf16 v[8:11], v[32:35], v[68:71], v[8:11]
    ds_read_b64 v[96:97], v4 offset:3584
    ds_read_b64 v[98:99], v4 offset:3592
    v_mfma_f32_16x16x32_bf16 v[8:11], v[36:39], v[64:67], v[8:11]
    ds_read_b128 v[128:131], v5 offset:0
    ds_read_b64 v[100:101], v4 offset:3072
    v_mfma_f32_16x16x32_bf16 v[12:15], v[32:35], v[72:75], v[12:15]
    ds_read_b64 v[102:103], v4 offset:3080
    ds_read_b128 v[132:135], v5 offset:512
    v_mfma_f32_16x16x32_bf16 v[12:15], v[36:39], v[68:71], v[12:15]
    ds_read_b64 v[104:105], v4 offset:2560
    ds_read_b64 v[106:107], v4 offset:2568
    v_mfma_f32_16x16x32_bf16 v[12:15], v[40:43], v[64:67], v[12:15]
    ds_read_b128 v[136:139], v5 offset:1024
    ds_read_b64 v[108:109], v4 offset:2048
    v_mfma_f32_16x16x32_bf16 v[16:19], v[32:35], v[84:87], v[16:19]
    ds_read_b64 v[110:111], v4 offset:2056
    ds_read_b128 v[140:143], v5 offset:1536
    v_mfma_f32_16x16x32_bf16 v[16:19], v[36:39], v[80:83], v[16:19]
    ds_read_b64 v[112:113], v4 offset:1536
    ds_read_b64 v[114:115], v4 offset:1544
    v_mfma_f32_16x16x32_bf16 v[16:19], v[40:43], v[76:79], v[16:19]
    ds_read_b128 v[144:147], v5 offset:2048
    ds_read_b64 v[116:117], v4 offset:1024
    v_mfma_f32_16x16x32_bf16 v[16:19], v[44:47], v[72:75], v[16:19]
    ds_read_b64 v[118:119], v4 offset:1032
    ds_read_b128 v[148:151], v5 offset:2560
    v_mfma_f32_16x16x32_bf16 v[16:19], v[48:51], v[68:71], v[16:19]
    ds_read_b64 v[120:121], v4 offset:512
    ds_read_b64 v[122:123], v4 offset:520
    v_mfma_f32_16x16x32_bf16 v[16:19], v[52:55], v[64:67], v[16:19]
    ds_read_b128 v[152:155], v5 offset:3072
    v_mfma_f32_16x16x32_bf16 v[20:23], v[32:35], v[88:91], v[20:23]
    v_mfma_f32_16x16x32_bf16 v[20:23], v[36:39], v[84:87], v[20:23]
    v_mfma_f32_16x16x32_bf16 v[20:23], v[40:43], v[80:83], v[20:23]
    v_mfma_f32_16x16x32_bf16 v[20:23], v[44:47], v[76:79], v[20:23]
    v_mfma_f32_16x16x32_bf16 v[20:23], v[48:51], v[72:75], v[20:23]
    v_mfma_f32_16x16x32_bf16 v[20:23], v[52:55], v[68:71], v[20:23]
    v_mfma_f32_16x16x32_bf16 v[20:23], v[56:59], v[64:67], v[20:23]
    s_waitcnt lgkmcnt(0)
    v_mfma_f32_16x16x32_bf16 v[8:11], v[96:99], v[132:135], v[8:11]
    v_mfma_f32_16x16x32_bf16 v[8:11], v[100:103], v[128:131], v[8:11]
    v_mfma_f32_16x16x32_bf16 v[12:15], v[96:99], v[136:139], v[12:15]
    v_mfma_f32_16x16x32_bf16 v[12:15], v[100:103], v[132:135], v[12:15]
    v_mfma_f32_16x16x32_bf16 v[12:15], v[104:107], v[128:131], v[12:15]
    v_mfma_f32_16x16x32_bf16 v[16:19], v[96:99], v[148:151], v[16:19]
    v_mfma_f32_16x16x32_bf16 v[16:19], v[100:103], v[144:147], v[16:19]
    v_mfma_f32_16x16x32_bf16 v[16:19], v[104:107], v[140:143], v[16:19]
    v_mfma_f32_16x16x32_bf16 v[16:19], v[108:111], v[136:139], v[16:19]
    v_mfma_f32_16x16x32_bf16 v[16:19], v[112:115], v[132:135], v[16:19]
    v_mfma_f32_16x16x32_bf16 v[16:19], v[116:119], v[128:131], v[16:19]
    v_mfma_f32_16x16x32_bf16 v[20:23], v[96:99], v[152:155], v[20:23]
    v_mfma_f32_16x16x32_bf16 v[20:23], v[100:103], v[148:151], v[20:23]
    v_mfma_f32_16x16x32_bf16 v[20:23], v[104:107], v[144:147], v[20:23]
    v_mfma_f32_16x16x32_bf16 v[20:23], v[108:111], v[140:143], v[20:23]
    v_mfma_f32_16x16x32_bf16 v[20:23], v[112:115], v[136:139], v[20:23]
    v_mfma_f32_16x16x32_bf16 v[20:23], v[116:119], v[132:135], v[20:23]
    v_mfma_f32_16x16x32_bf16 v[20:23], v[120:123], v[128:131], v[20:23]
    ds_read_b64 v[32:33], v7 offset:3072
    ds_read_b64 v[34:35], v7 offset:2560
    ds_read_b64 v[36:37], v7 offset:1024
    ds_read_b64 v[38:39], v7 offset:512
    s_waitcnt lgkmcnt(0)
    s_nop 7
    v_and_b32 v48, 0xffff0000, v33
    v_lshlrev_b32 v49, 16, v33
    v_and_b32 v50, 0xffff0000, v32
    v_lshlrev_b32 v51, 16, v32
    v_fma_f32 v8, v48, s70, v8
    v_fma_f32 v9, v49, s70, v9
    v_fma_f32 v10, v50, s70, v10
    v_fma_f32 v11, v51, s70, v11
    v_cvt_pk_bf16_f32 v56, v8, v9
    v_cvt_pk_bf16_f32 v57, v10, v11
    buffer_store_dwordx2 v[56:57], v6, s[12:15], s64 offen offset:512 sc1
    v_and_b32 v48, 0xffff0000, v35
    v_lshlrev_b32 v49, 16, v35
    v_and_b32 v50, 0xffff0000, v34
    v_lshlrev_b32 v51, 16, v34
    v_fma_f32 v12, v48, s70, v12
    v_fma_f32 v13, v49, s70, v13
    v_fma_f32 v14, v50, s70, v14
    v_fma_f32 v15, v51, s70, v15
    v_cvt_pk_bf16_f32 v58, v12, v13
    v_cvt_pk_bf16_f32 v59, v14, v15
    buffer_store_dwordx2 v[58:59], v6, s[12:15], s64 offen offset:1024 sc1
    v_and_b32 v48, 0xffff0000, v37
    v_lshlrev_b32 v49, 16, v37
    v_and_b32 v50, 0xffff0000, v36
    v_lshlrev_b32 v51, 16, v36
    v_fma_f32 v16, v48, s70, v16
    v_fma_f32 v17, v49, s70, v17
    v_fma_f32 v18, v50, s70, v18
    v_fma_f32 v19, v51, s70, v19
    v_cvt_pk_bf16_f32 v60, v16, v17
    v_cvt_pk_bf16_f32 v61, v18, v19
    buffer_store_dwordx2 v[60:61], v6, s[12:15], s64 offen offset:2560 sc1
    v_and_b32 v48, 0xffff0000, v39
    v_lshlrev_b32 v49, 16, v39
    v_and_b32 v50, 0xffff0000, v38
    v_lshlrev_b32 v51, 16, v38
    v_fma_f32 v20, v48, s70, v20
    v_fma_f32 v21, v49, s70, v21
    v_fma_f32 v22, v50, s70, v22
    v_fma_f32 v23, v51, s70, v23
    v_cvt_pk_bf16_f32 v62, v20, v21
    v_cvt_pk_bf16_f32 v63, v22, v23
    buffer_store_dwordx2 v[62:63], v6, s[12:15], s64 offen offset:3072 sc1
L_cdone_21:
    v_lshrrev_b32 v2, 4, v0
    v_xor_b32 v2, v2, v0
    v_and_b32 v2, 1, v2
    v_cmp_eq_u32 vcc, 0, v2
    v_mov_b32 v3, 0x3f803f80
    s_nop 1
    v_cndmask_b32 v52, 0, v3, vcc
    v_cndmask_b32 v53, 0, v3, vcc
    v_cndmask_b32 v54, 0, v3, vcc
    v_cndmask_b32 v55, 0, v3, vcc
    s_lshl_b32 s31, s28, 11
    s_add_u32 s31, s31, 49152
    v_add_u32 v2, s31, v1
    v_and_b32 v3, 31, v0
    v_lshlrev_b32 v3, 2, v3
    v_add_u32 v3, 160832, v3
    s_barrier
    ds_read_b128 v[8:11], v2
    ds_read_b128 v[12:15], v2 offset:1024
    ds_read_b32 v6, v3
    s_waitcnt lgkmcnt(0)
    v_dot2_f32_bf16 v4, v8, v8, 0
    v_dot2_f32_bf16 v4, v9, v9, v4
    v_dot2_f32_bf16 v4, v10, v10, v4
    v_dot2_f32_bf16 v4, v11, v11, v4
    v_dot2_f32_bf16 v4, v12, v12, v4
    v_dot2_f32_bf16 v4, v13, v13, v4
    v_dot2_f32_bf16 v4, v14, v14, v4
    v_dot2_f32_bf16 v4, v15, v15, v4
    s_nop 1
    v_max_f32_dpp v6, v6, v6 quad_perm:[1,0,3,2] row_mask:0xf bank_mask:0xf
    s_nop 1
    v_max_f32_dpp v6, v6, v6 quad_perm:[2,3,0,1] row_mask:0xf bank_mask:0xf
    s_nop 1
    v_max_f32_dpp v6, v6, v6 row_half_mirror row_mask:0xf bank_mask:0xf
    s_nop 1
    v_max_f32_dpp v6, v6, v6 row_mirror row_mask:0xf bank_mask:0xf
    s_nop 1
    v_mov_b32 v7, v6
    v_mov_b32 v5, v4
    s_nop 1
    v_permlane16_swap_b32 v7, v6
    v_permlane32_swap_b32 v5, v4
    s_nop 1
    v_max_f32 v6, v6, v7
    v_add_f32 v4, v4, v5
    v_mul_f32 v4, v6, v4
    v_sqrt_f32 v4, v4
    s_nop 0
    v_sub_f32 v4, 0, v4
    s_mov_b32 s7, 0
    s_setprio 1
    s_branch L_go_22
L_restart_23:
    s_barrier
L_go_22:
    v_mov_b32 v16, v4
    v_mov_b32 v17, v4
    v_mov_b32 v18, v4
    v_mov_b32 v19, v4
    v_mov_b32 v20, v4
    v_mov_b32 v21, v4
    v_mov_b32 v22, v4
    v_mov_b32 v23, v4
    v_mov_b32 v24, v4
    v_mov_b32 v25, v4
    v_mov_b32 v26, v4
    v_mov_b32 v27, v4
    v_mov_b32 v28, v4
    v_mov_b32 v29, v4
    v_mov_b32 v30, v4
    v_mov_b32 v31, v4
    v_mov_b32 v32, 0
    v_mov_b32 v33, 0
    v_mov_b32 v34, 0
    v_mov_b32 v35, 0
    v_mov_b32 v36, 0
    v_mov_b32 v37, 0
    v_mov_b32 v38, 0
    v_mov_b32 v39, 0
    v_mov_b32 v40, 0
    v_mov_b32 v41, 0
    v_mov_b32 v42, 0
    v_mov_b32 v43, 0
    v_mov_b32 v44, 0
    v_mov_b32 v45, 0
    v_mov_b32 v46, 0
    v_mov_b32 v47, 0
    v_mov_b32 v48, 0
    v_mov_b32 v49, 0
    v_mov_b32 v50, 0
    v_mov_b32 v51, 0
    v_mov_b32 v100, 0
    v_mov_b32 v101, 0
    v_mov_b32 v102, 0
    v_mov_b32 v103, 0
    v_mov_b32 v140, 0
    v_mov_b32 v141, 0
    v_mov_b32 v142, 0
    v_mov_b32 v143, 0
    v_mov_b32 v2, v1
    v_add_u32 v3, 16384, v1
    ds_read_b128 v[112:115], v2 offset:0
    ds_read_b128 v[116:119], v2 offset:1024
    ds_read_b128 v[120:123], v2 offset:2048
    ds_read_b128 v[124:127], v2 offset:3072
    ds_read_b128 v[128:131], v2 offset:8192
    ds_read_b128 v[132:135], v2 offset:9216
    s_waitcnt lgkmcnt(4)
    v_mfma_f32_32x32x16_bf16 v[64:79], v[112:115], v[8:11], v[16:31]
    v_mfma_f32_32x32x16_bf16 v[64:79], v[116:119], v[12:15], v[64:79]
    s_mov_b32 s8, 0
    s_waitcnt vmcnt(0)
    s_nop 11
L_loop_24:
    s_waitcnt lgkmcnt(2)
    v_mfma_f32_32x32x16_bf16 v[80:95], v[120:123], v[8:11], v[16:31]
    v_exp_f32 v64, v64
    v_exp_f32 v65, v65
    v_exp_f32 v66, v66
    v_exp_f32 v67, v67
    v_mfma_f32_32x32x16_bf16 v[80:95], v[124:127], v[12:15], v[80:95]
    v_exp_f32 v68, v68
    v_exp_f32 v69, v69
    ds_read_b128 v[112:115], v2 offset:4096
    ds_read_b128 v[116:119], v2 offset:5120
    v_exp_f32 v70, v70
    v_exp_f32 v71, v71
    v_mfma_f32_32x32x16_bf16 v[32:47], v[140:143], v[100:103], v[32:47]
    v_cvt_pk_bf16_f32 v96, v64, v65
    v_cvt_pk_bf16_f32 v97, v66, v67
    v_cvt_pk_bf16_f32 v98, v68, v69
    v_cvt_pk_bf16_f32 v99, v70, v71
    v_exp_f32 v72, v72
    v_mfma_f32_16x16x32_bf16 v[48:51], v[52:55], v[100:103], v[48:51]
    v_exp_f32 v73, v73
    v_exp_f32 v74, v74
    v_exp_f32 v75, v75
    s_waitcnt lgkmcnt(2)
    v_mfma_f32_32x32x16_bf16 v[32:47], v[128:131], v[96:99], v[32:47]
    ds_read_b128 v[136:139], v2 offset:10240
    ds_read_b128 v[140:143], v2 offset:11264
    v_exp_f32 v76, v76
    v_exp_f32 v77, v77
    v_exp_f32 v78, v78
    v_exp_f32 v79, v79
    v_mfma_f32_16x16x32_bf16 v[48:51], v[52:55], v[96:99], v[48:51]
    v_cvt_pk_bf16_f32 v100, v72, v73
    v_cvt_pk_bf16_f32 v101, v74, v75
    v_cvt_pk_bf16_f32 v102, v76, v77
    v_cvt_pk_bf16_f32 v103, v78, v79
    s_waitcnt lgkmcnt(2)
    v_mfma_f32_32x32x16_bf16 v[64:79], v[112:115], v[8:11], v[16:31]
    v_exp_f32 v80, v80
    v_exp_f32 v81, v81
    v_exp_f32 v82, v82
    v_exp_f32 v83, v83
    v_mfma_f32_32x32x16_bf16 v[64:79], v[116:119], v[12:15], v[64:79]
    v_exp_f32 v84, v84
    v_exp_f32 v85, v85
    ds_read_b128 v[120:123], v2 offset:6144
    ds_read_b128 v[124:127], v2 offset:7168
    v_exp_f32 v86, v86
    v_exp_f32 v87, v87
    v_mfma_f32_32x32x16_bf16 v[32:47], v[132:135], v[100:103], v[32:47]
    v_cvt_pk_bf16_f32 v96, v80, v81
    v_cvt_pk_bf16_f32 v97, v82, v83
    v_cvt_pk_bf16_f32 v98, v84, v85
    v_cvt_pk_bf16_f32 v99, v86, v87
    v_exp_f32 v88, v88
    v_mfma_f32_16x16x32_bf16 v[48:51], v[52:55], v[100:103], v[48:51]
    v_exp_f32 v89, v89
    v_exp_f32 v90, v90
    v_exp_f32 v91, v91
    s_waitcnt lgkmcnt(2)
    v_mfma_f32_32x32x16_bf16 v[32:47], v[136:139], v[96:99], v[32:47]
    ds_read_b128 v[128:131], v2 offset:12288
    ds_read_b128 v[132:135], v2 offset:13312
    v_exp_f32 v92, v92
    v_exp_f32 v93, v93
    v_exp_f32 v94, v94
    v_exp_f32 v95, v95
    v_mfma_f32_16x16x32_bf16 v[48:51], v[52:55], v[96:99], v[48:51]
    v_cvt_pk_bf16_f32 v100, v88, v89
    v_cvt_pk_bf16_f32 v101, v90, v91
    v_cvt_pk_bf16_f32 v102, v92, v93
    v_cvt_pk_bf16_f32 v103, v94, v95
    s_waitcnt lgkmcnt(2)
    v_mfma_f32_32x32x16_bf16 v[80:95], v[120:123], v[8:11], v[16:31]
    v_exp_f32 v64, v64
    v_exp_f32 v65, v65
    v_exp_f32 v66, v66
    v_exp_f32 v67, v67
    v_mfma_f32_32x32x16_bf16 v[80:95], v[124:127], v[12:15], v[80:95]
    v_exp_f32 v68, v68
    v_exp_f32 v69, v69
    s_barrier
    ds_read_b128 v[112:115], v3 offset:0
    ds_read_b128 v[116:119], v3 offset:1024
    v_exp_f32 v70, v70
    v_exp_f32 v71, v71
    v_mfma_f32_32x32x16_bf16 v[32:47], v[140:143], v[100:103], v[32:47]
    v_cvt_pk_bf16_f32 v96, v64, v65
    v_cvt_pk_bf16_f32 v97, v66, v67
    v_cvt_pk_bf16_f32 v98, v68, v69
    v_cvt_pk_bf16_f32 v99, v70, v71
    v_exp_f32 v72, v72
    v_mfma_f32_16x16x32_bf16 v[48:51], v[52:55], v[100:103], v[48:51]
    v_exp_f32 v73, v73
    v_exp_f32 v74, v74
    v_exp_f32 v75, v75
    s_waitcnt lgkmcnt(2)
    v_mfma_f32_32x32x16_bf16 v[32:47], v[128:131], v[96:99], v[32:47]
    ds_read_b128 v[136:139], v2 offset:14336
    ds_read_b128 v[140:143], v2 offset:15360
    v_exp_f32 v76, v76
    v_exp_f32 v77, v77
    v_exp_f32 v78, v78
    v_exp_f32 v79, v79
    v_mfma_f32_16x16x32_bf16 v[48:51], v[52:55], v[96:99], v[48:51]
    v_cvt_pk_bf16_f32 v100, v72, v73
    v_cvt_pk_bf16_f32 v101, v74, v75
    v_cvt_pk_bf16_f32 v102, v76, v77
    v_cvt_pk_bf16_f32 v103, v78, v79
    s_waitcnt lgkmcnt(2)
    v_mfma_f32_32x32x16_bf16 v[64:79], v[112:115], v[8:11], v[16:31]
    v_exp_f32 v80, v80
    v_exp_f32 v81, v81
    v_exp_f32 v82, v82
    v_exp_f32 v83, v83
    v_mfma_f32_32x32x16_bf16 v[64:79], v[116:119], v[12:15], v[64:79]
    v_exp_f32 v84, v84
    v_exp_f32 v85, v85
    ds_read_b128 v[120:123], v3 offset:2048
    ds_read_b128 v[124:127], v3 offset:3072
    v_exp_f32 v86, v86
    v_exp_f32 v87, v87
    v_mfma_f32_32x32x16_bf16 v[32:47], v[132:135], v[100:103], v[32:47]
    v_cvt_pk_bf16_f32 v96, v80, v81
    v_cvt_pk_bf16_f32 v97, v82, v83
    v_cvt_pk_bf16_f32 v98, v84, v85
    v_cvt_pk_bf16_f32 v99, v86, v87
    v_exp_f32 v88, v88
    v_mfma_f32_16x16x32_bf16 v[48:51], v[52:55], v[100:103], v[48:51]
    v_exp_f32 v89, v89
    v_exp_f32 v90, v90
    v_exp_f32 v91, v91
    s_waitcnt lgkmcnt(2)
    v_mfma_f32_32x32x16_bf16 v[32:47], v[136:139], v[96:99], v[32:47]
    ds_read_b128 v[128:131], v3 offset:8192
    ds_read_b128 v[132:135], v3 offset:9216
    v_exp_f32 v92, v92
    v_exp_f32 v93, v93
    v_exp_f32 v94, v94
    v_exp_f32 v95, v95
    v_mfma_f32_16x16x32_bf16 v[48:51], v[52:55], v[96:99], v[48:51]
    v_mov_b32 v2, v3
    v_add_u32 v3, 16384, v3
    v_and_b32 v3, 0xffff, v3
    s_add_u32 s8, s8, 1
    s_cmp_lt_u32 s8, 16
    v_cvt_pk_bf16_f32 v100, v88, v89
    v_cvt_pk_bf16_f32 v101, v90, v91
    v_cvt_pk_bf16_f32 v102, v92, v93
    v_cvt_pk_bf16_f32 v103, v94, v95
    s_cbranch_scc1 L_loop_24
    s_nop 1
    v_mfma_f32_32x32x16_bf16 v[32:47], v[140:143], v[100:103], v[32:47]
    v_mfma_f32_16x16x32_bf16 v[48:51], v[52:55], v[100:103], v[48:51]
    s_waitcnt lgkmcnt(0)
    s_nop 15
    v_and_b32 v5, 16, v0
    v_cmp_ne_u32 vcc, 0, v5
    s_nop 1
    v_cndmask_b32 v5, v48, v49, vcc
    s_cmp_lg_u32 s7, 0
    s_cbranch_scc1 L_ok_25
    v_mov_b32 v6, 562036736
    v_cmp_nge_f32 vcc, v5, v6
    s_cmp_eq_u64 vcc, 0
    s_cbranch_scc1 L_nf_26
    v_mov_b32 v6, 160768
    v_mov_b32 v7, 1
    ds_write_b32 v6, v7
L_nf_26:
    s_waitcnt lgkmcnt(0)
    s_barrier
    v_mov_b32 v6, 160768
    ds_read_b32 v7, v6
    s_waitcnt lgkmcnt(0)
    v_readfirstlane_b32 s31, v7
    s_nop 3
    s_cmp_eq_u32 s31, 0
    s_cbranch_scc1 L_ok_25
    s_mov_b32 s7, 1
    v_mov_b32 v4, 0xff800000
    s_lshl_b32 s31, s29, 17
    s_add_u32 s31, s31, 4194304
    s_mov_b32 s8, 0
L_fb_27:
    buffer_load_dwordx4 v[112:115], v1, s[12:15], s31 offen sc1
    buffer_load_dwordx4 v[116:119], v1, s[12:15], s31 offen offset:1024 sc1
    s_waitcnt vmcnt(0)
    v_mfma_f32_32x32x16_bf16 v[64:79], v[112:115], v[8:11], 0
    v_mfma_f32_32x32x16_bf16 v[64:79], v[116:119], v[12:15], v[64:79]
    s_nop 15
    v_max3_f32 v4, v4, v64, v65
    v_max3_f32 v4, v4, v66, v67
    v_max3_f32 v4, v4, v68, v69
    v_max3_f32 v4, v4, v70, v71
    v_max3_f32 v4, v4, v72, v73
    v_max3_f32 v4, v4, v74, v75
    v_max3_f32 v4, v4, v76, v77
    v_max3_f32 v4, v4, v78, v79
    s_add_u32 s31, s31, 2048
    s_add_u32 s8, s8, 1
    s_cmp_lt_u32 s8, 64
    s_cbranch_scc1 L_fb_27
    v_mov_b32 v5, v4
    s_nop 1
    v_permlane32_swap_b32 v5, v4
    s_nop 1
    v_max_f32 v4, v4, v5
    v_sub_f32 v4, 0, v4
    s_branch L_restart_23
L_ok_25:
    v_rcp_f32 v5, v5
    s_nop 0
    v_mul_f32 v32, v32, v5
    v_mul_f32 v33, v33, v5
    v_mul_f32 v34, v34, v5
    v_mul_f32 v35, v35, v5
    v_mul_f32 v36, v36, v5
    v_mul_f32 v37, v37, v5
    v_mul_f32 v38, v38, v5
    v_mul_f32 v39, v39, v5
    v_mul_f32 v40, v40, v5
    v_mul_f32 v41, v41, v5
    v_mul_f32 v42, v42, v5
    v_mul_f32 v43, v43, v5
    v_mul_f32 v44, v44, v5
    v_mul_f32 v45, v45, v5
    v_mul_f32 v46, v46, v5
    v_mul_f32 v47, v47, v5
    v_cvt_pk_bf16_f32 v96, v32, v33
    v_cvt_pk_bf16_f32 v97, v34, v35
    v_cvt_pk_bf16_f32 v98, v36, v37
    v_cvt_pk_bf16_f32 v99, v38, v39
    v_cvt_pk_bf16_f32 v100, v40, v41
    v_cvt_pk_bf16_f32 v101, v42, v43
    v_cvt_pk_bf16_f32 v102, v44, v45
    v_cvt_pk_bf16_f32 v103, v46, v47
    s_lshl_b32 s31, s30, 3
    s_add_u32 s31, s31, s28
    s_lshl_b32 s31, s31, 5
    s_add_u32 s31, s31, s29
    s_lshl_b32 s31, s31, 11
    s_add_u32 s31, s31, 12582912
    buffer_store_dwordx4 v[96:99], v1, s[12:15], s31 offen sc1
    buffer_store_dwordx4 v[100:103], v1, s[12:15], s31 offen offset:1024 sc1
    s_waitcnt vmcnt(0)
    s_barrier
    s_cmp_lt_u32 s28, 4
    s_cbranch_scc1 L_g3_28
    s_endpgm
L_g3_28:
    s_cmp_lg_u32 s28, 0
    s_cbranch_scc1 L_np3_29
    s_lshl_b32 s31, s30, 8
    s_lshl_b32 s95, s29, 2
    s_add_u32 s31, s31, s95
    s_add_u32 s31, s31, 31522816
    v_mov_b32 v8, 0
    v_mov_b32 v9, s9
    s_mov_b64 exec, 1
    buffer_store_dword v9, v8, s[12:15], s31 offen sc1
    s_mov_b64 exec, -1
    s_lshr_b32 s8, s3, 1
    s_lshl_b32 s94, s8, 8
    s_add_u32 s94, s94, 31522816
    v_and_b32 v8, 31, v0
    v_lshlrev_b32 v8, 2, v8
    s_mov_b32 s95, 0
L_poll_30:
    buffer_load_dword v9, v8, s[12:15], s94 offen sc1
    s_add_u32 s95, s95, 1
    s_waitcnt vmcnt(0)
    v_cmp_ne_u32 vcc, s9, v9
    s_cmp_eq_u64 vcc, 0
    s_cbranch_scc1 L_polld_31
    s_sleep 4
    s_cmp_lt_u32 s95, 0x400000
    s_cbranch_scc1 L_poll_30
L_polld_31:
L_np3_29:
    s_lshl_b32 s60, s3, 2
    s_add_u32 s60, s60, s28
    s_lshl_b32 s61, s60, 16
    s_add_u32 s61, s61, 12582912
    v_and_b32 v2, 15, v0
    v_lshrrev_b32 v3, 2, v2
    v_and_b32 v2, 3, v2
    v_lshrrev_b32 v4, 4, v0
    v_and_b32 v4, 1, v4
    v_lshlrev_b32 v4, 5, v4
    v_lshl_add_u32 v4, v2, 3, v4
    v_lshrrev_b32 v5, 1, v3
    v_and_b32 v5, 1, v5
    v_lshlrev_b32 v5, 6, v5
    v_xor_b32 v4, v4, v5
    v_lshrrev_b32 v5, 5, v0
    v_lshl_add_u32 v3, v5, 2, v3
    v_lshl_add_u32 v10, v3, 7, v4
    v_xor_b32 v11, 64, v10
    v_mov_b32 v32, 0
    v_mov_b32 v33, 0
    v_mov_b32 v34, 0
    v_mov_b32 v35, 0
    v_mov_b32 v36, 0
    v_mov_b32 v37, 0
    v_mov_b32 v38, 0
    v_mov_b32 v39, 0
    v_mov_b32 v40, 0
    v_mov_b32 v41, 0
    v_mov_b32 v42, 0
    v_mov_b32 v43, 0
    v_mov_b32 v44, 0
    v_mov_b32 v45, 0
    v_mov_b32 v46, 0
    v_mov_b32 v47, 0
    v_mov_b32 v48, 0
    v_mov_b32 v49, 0
    v_mov_b32 v50, 0
    v_mov_b32 v51, 0
    v_mov_b32 v52, 0
    v_mov_b32 v53, 0
    v_mov_b32 v54, 0
    v_mov_b32 v55, 0
    v_mov_b32 v56, 0
    v_mov_b32 v57, 0
    v_mov_b32 v58, 0
    v_mov_b32 v59, 0
    v_mov_b32 v60, 0
    v_mov_b32 v61, 0
    v_mov_b32 v62, 0
    v_mov_b32 v63, 0
    s_barrier
    s_add_u32 s31, s61, 0
    buffer_load_dwordx4 v[64:67], v1, s[12:15], s31 offen offset:0 sc1
    s_add_u32 s31, s61, 0
    buffer_load_dwordx4 v[68:71], v1, s[12:15], s31 offen offset:1024 sc1
    s_add_u32 s31, s61, 0
    buffer_load_dwordx4 v[72:75], v1, s[12:15], s31 offen offset:2048 sc1
    s_add_u32 s31, s61, 0
    buffer_load_dwordx4 v[76:79], v1, s[12:15], s31 offen offset:3072 sc1
    s_add_u32 s31, s61, 4096
    buffer_load_dwordx4 v[80:83], v1, s[12:15], s31 offen offset:0 sc1
    s_add_u32 s31, s61, 4096
    buffer_load_dwordx4 v[84:87], v1, s[12:15], s31 offen offset:1024 sc1
    s_add_u32 s31, s61, 4096
    buffer_load_dwordx4 v[88:91], v1, s[12:15], s31 offen offset:2048 sc1
    s_add_u32 s31, s61, 4096
    buffer_load_dwordx4 v[92:95], v1, s[12:15], s31 offen offset:3072 sc1
    s_add_u32 s31, s61, 8192
    buffer_load_dwordx4 v[96:99], v1, s[12:15], s31 offen offset:0 sc1
    s_add_u32 s31, s61, 8192
    buffer_load_dwordx4 v[100:103], v1, s[12:15], s31 offen offset:1024 sc1
    s_add_u32 s31, s61, 8192
    buffer_load_dwordx4 v[104:107], v1, s[12:15], s31 offen offset:2048 sc1
    s_add_u32 s31, s61, 8192
    buffer_load_dwordx4 v[108:111], v1, s[12:15], s31 offen offset:3072 sc1
    s_add_u32 s31, s61, 12288
    buffer_load_dwordx4 v[112:115], v1, s[12:15], s31 offen offset:0 sc1
    s_add_u32 s31, s61, 12288
    buffer_load_dwordx4 v[116:119], v1, s[12:15], s31 offen offset:1024 sc1
    s_add_u32 s31, s61, 12288
    buffer_load_dwordx4 v[120:123], v1, s[12:15], s31 offen offset:2048 sc1
    s_add_u32 s31, s61, 12288
    buffer_load_dwordx4 v[124:127], v1, s[12:15], s31 offen offset:3072 sc1
    s_add_u32 s31, s61, 16384
    buffer_load_dwordx4 v[128:131], v1, s[12:15], s31 offen offset:0 sc1
    s_add_u32 s31, s61, 16384
    buffer_load_dwordx4 v[132:135], v1, s[12:15], s31 offen offset:1024 sc1
    s_add_u32 s31, s61, 16384
    buffer_load_dwordx4 v[136:139], v1, s[12:15], s31 offen offset:2048 sc1
    s_add_u32 s31, s61, 16384
    buffer_load_dwordx4 v[140:143], v1, s[12:15], s31 offen offset:3072 sc1
    s_add_u32 s31, s61, 20480
    buffer_load_dwordx4 v[144:147], v1, s[12:15], s31 offen offset:0 sc1
    s_add_u32 s31, s61, 20480
    buffer_load_dwordx4 v[148:151], v1, s[12:15], s31 offen offset:1024 sc1
    s_add_u32 s31, s61, 20480
    buffer_load_dwordx4 v[152:155], v1, s[12:15], s31 offen offset:2048 sc1
    s_add_u32 s31, s61, 20480
    buffer_load_dwordx4 v[156:159], v1, s[12:15], s31 offen offset:3072 sc1
    v_add_u32 v8, 65536, v10
    v_add_u32 v9, 65536, v11
    ds_read_b64_tr_b16 v[16:17], v8 offset:0
    ds_read_b64_tr_b16 v[18:19], v8 offset:1024
    ds_read_b64_tr_b16 v[20:21], v9 offset:0
    ds_read_b64_tr_b16 v[22:23], v9 offset:1024
    ds_read_b64_tr_b16 v[24:25], v8 offset:2048
    ds_read_b64_tr_b16 v[26:27], v8 offset:3072
    ds_read_b64_tr_b16 v[28:29], v9 offset:2048
    ds_read_b64_tr_b16 v[30:31], v9 offset:3072
    s_waitcnt lgkmcnt(4)
    s_waitcnt vmcnt(23)
    v_mfma_f32_32x32x16_bf16 v[32:47], v[16:19], v[64:67], v[32:47]
    v_mfma_f32_32x32x16_bf16 v[48:63], v[20:23], v[64:67], v[48:63]
    s_add_u32 s31, s61, 24576
    buffer_load_dwordx4 v[64:67], v1, s[12:15], s31 offen offset:0 sc1
    ds_read_b64_tr_b16 v[16:17], v8 offset:4096
    ds_read_b64_tr_b16 v[18:19], v8 offset:5120
    ds_read_b64_tr_b16 v[20:21], v9 offset:4096
    ds_read_b64_tr_b16 v[22:23], v9 offset:5120
    s_waitcnt lgkmcnt(4)
    s_waitcnt vmcnt(23)
    v_mfma_f32_32x32x16_bf16 v[32:47], v[24:27], v[68:71], v[32:47]
    v_mfma_f32_32x32x16_bf16 v[48:63], v[28:31], v[68:71], v[48:63]
    s_add_u32 s31, s61, 24576
    buffer_load_dwordx4 v[68:71], v1, s[12:15], s31 offen offset:1024 sc1
    ds_read_b64_tr_b16 v[24:25], v8 offset:6144
    ds_read_b64_tr_b16 v[26:27], v8 offset:7168
    ds_read_b64_tr_b16 v[28:29], v9 offset:6144
    ds_read_b64_tr_b16 v[30:31], v9 offset:7168
    s_waitcnt lgkmcnt(4)
    s_waitcnt vmcnt(23)
    v_mfma_f32_32x32x16_bf16 v[32:47], v[16:19], v[72:75], v[32:47]
    v_mfma_f32_32x32x16_bf16 v[48:63], v[20:23], v[72:75], v[48:63]
    s_add_u32 s31, s61, 24576
    buffer_load_dwordx4 v[72:75], v1, s[12:15], s31 offen offset:2048 sc1
    ds_read_b64_tr_b16 v[16:17], v8 offset:8192
    ds_read_b64_tr_b16 v[18:19], v8 offset:9216
    ds_read_b64_tr_b16 v[20:21], v9 offset:8192
    ds_read_b64_tr_b16 v[22:23], v9 offset:9216
    s_waitcnt lgkmcnt(4)
    s_waitcnt vmcnt(23)
    v_mfma_f32_32x32x16_bf16 v[32:47], v[24:27], v[76:79], v[32:47]
    v_mfma_f32_32x32x16_bf16 v[48:63], v[28:31], v[76:79], v[48:63]
    s_add_u32 s31, s61, 24576
    buffer_load_dwordx4 v[76:79], v1, s[12:15], s31 offen offset:3072 sc1
    ds_read_b64_tr_b16 v[24:25], v8 offset:10240
    ds_read_b64_tr_b16 v[26:27], v8 offset:11264
    ds_read_b64_tr_b16 v[28:29], v9 offset:10240
    ds_read_b64_tr_b16 v[30:31], v9 offset:11264
    s_waitcnt lgkmcnt(4)
    s_waitcnt vmcnt(23)
    v_mfma_f32_32x32x16_bf16 v[32:47], v[16:19], v[80:83], v[32:47]
    v_mfma_f32_32x32x16_bf16 v[48:63], v[20:23], v[80:83], v[48:63]
    s_add_u32 s31, s61, 28672
    buffer_load_dwordx4 v[80:83], v1, s[12:15], s31 offen offset:0 sc1
    ds_read_b64_tr_b16 v[16:17], v8 offset:12288
    ds_read_b64_tr_b16 v[18:19], v8 offset:13312
    ds_read_b64_tr_b16 v[20:21], v9 offset:12288
    ds_read_b64_tr_b16 v[22:23], v9 offset:13312
    s_waitcnt lgkmcnt(4)
    s_waitcnt vmcnt(23)
    v_mfma_f32_32x32x16_bf16 v[32:47], v[24:27], v[84:87], v[32:47]
    v_mfma_f32_32x32x16_bf16 v[48:63], v[28:31], v[84:87], v[48:63]
    s_add_u32 s31, s61, 28672
    buffer_load_dwordx4 v[84:87], v1, s[12:15], s31 offen offset:1024 sc1
    ds_read_b64_tr_b16 v[24:25], v8 offset:14336
    ds_read_b64_tr_b16 v[26:27], v8 offset:15360
    ds_read_b64_tr_b16 v[28:29], v9 offset:14336
    ds_read_b64_tr_b16 v[30:31], v9 offset:15360
    s_waitcnt lgkmcnt(4)
    s_waitcnt vmcnt(23)
    v_mfma_f32_32x32x16_bf16 v[32:47], v[16:19], v[88:91], v[32:47]
    v_mfma_f32_32x32x16_bf16 v[48:63], v[20:23], v[88:91], v[48:63]
    s_add_u32 s31, s61, 28672
    buffer_load_dwordx4 v[88:91], v1, s[12:15], s31 offen offset:2048 sc1
    s_waitcnt lgkmcnt(0)
    s_waitcnt vmcnt(23)
    v_mfma_f32_32x32x16_bf16 v[32:47], v[24:27], v[92:95], v[32:47]
    v_mfma_f32_32x32x16_bf16 v[48:63], v[28:31], v[92:95], v[48:63]
    s_add_u32 s31, s61, 28672
    buffer_load_dwordx4 v[92:95], v1, s[12:15], s31 offen offset:3072 sc1
    v_add_u32 v8, 81920, v10
    v_add_u32 v9, 81920, v11
    ds_read_b64_tr_b16 v[16:17], v8 offset:0
    ds_read_b64_tr_b16 v[18:19], v8 offset:1024
    ds_read_b64_tr_b16 v[20:21], v9 offset:0
    ds_read_b64_tr_b16 v[22:23], v9 offset:1024
    ds_read_b64_tr_b16 v[24:25], v8 offset:2048
    ds_read_b64_tr_b16 v[26:27], v8 offset:3072
    ds_read_b64_tr_b16 v[28:29], v9 offset:2048
    ds_read_b64_tr_b16 v[30:31], v9 offset:3072
    s_waitcnt lgkmcnt(4)
    s_waitcnt vmcnt(23)
    v_mfma_f32_32x32x16_bf16 v[32:47], v[16:19], v[96:99], v[32:47]
    v_mfma_f32_32x32x16_bf16 v[48:63], v[20:23], v[96:99], v[48:63]
    s_add_u32 s31, s61, 32768
    buffer_load_dwordx4 v[96:99], v1, s[12:15], s31 offen offset:0 sc1
    ds_read_b64_tr_b16 v[16:17], v8 offset:4096
    ds_read_b64_tr_b16 v[18:19], v8 offset:5120
    ds_read_b64_tr_b16 v[20:21], v9 offset:4096
    ds_read_b64_tr_b16 v[22:23], v9 offset:5120
    s_waitcnt lgkmcnt(4)
    s_waitcnt vmcnt(23)
    v_mfma_f32_32x32x16_bf16 v[32:47], v[24:27], v[100:103], v[32:47]
    v_mfma_f32_32x32x16_bf16 v[48:63], v[28:31], v[100:103], v[48:63]
    s_add_u32 s31, s61, 32768
    buffer_load_dwordx4 v[100:103], v1, s[12:15], s31 offen offset:1024 sc1
    ds_read_b64_tr_b16 v[24:25], v8 offset:6144
    ds_read_b64_tr_b16 v[26:27], v8 offset:7168
    ds_read_b64_tr_b16 v[28:29], v9 offset:6144
    ds_read_b64_tr_b16 v[30:31], v9 offset:7168
    s_waitcnt lgkmcnt(4)
    s_waitcnt vmcnt(23)
    v_mfma_f32_32x32x16_bf16 v[32:47], v[16:19], v[104:107], v[32:47]
    v_mfma_f32_32x32x16_bf16 v[48:63], v[20:23], v[104:107], v[48:63]
    s_add_u32 s31, s61, 32768
    buffer_load_dwordx4 v[104:107], v1, s[12:15], s31 offen offset:2048 sc1
    ds_read_b64_tr_b16 v[16:17], v8 offset:8192
    ds_read_b64_tr_b16 v[18:19], v8 offset:9216
    ds_read_b64_tr_b16 v[20:21], v9 offset:8192
    ds_read_b64_tr_b16 v[22:23], v9 offset:9216
    s_waitcnt lgkmcnt(4)
    s_waitcnt vmcnt(23)
    v_mfma_f32_32x32x16_bf16 v[32:47], v[24:27], v[108:111], v[32:47]
    v_mfma_f32_32x32x16_bf16 v[48:63], v[28:31], v[108:111], v[48:63]
    s_add_u32 s31, s61, 32768
    buffer_load_dwordx4 v[108:111], v1, s[12:15], s31 offen offset:3072 sc1
    ds_read_b64_tr_b16 v[24:25], v8 offset:10240
    ds_read_b64_tr_b16 v[26:27], v8 offset:11264
    ds_read_b64_tr_b16 v[28:29], v9 offset:10240
    ds_read_b64_tr_b16 v[30:31], v9 offset:11264
    s_waitcnt lgkmcnt(4)
    s_waitcnt vmcnt(23)
    v_mfma_f32_32x32x16_bf16 v[32:47], v[16:19], v[112:115], v[32:47]
    v_mfma_f32_32x32x16_bf16 v[48:63], v[20:23], v[112:115], v[48:63]
    s_add_u32 s31, s61, 36864
    buffer_load_dwordx4 v[112:115], v1, s[12:15], s31 offen offset:0 sc1
    ds_read_b64_tr_b16 v[16:17], v8 offset:12288
    ds_read_b64_tr_b16 v[18:19], v8 offset:13312
    ds_read_b64_tr_b16 v[20:21], v9 offset:12288
    ds_read_b64_tr_b16 v[22:23], v9 offset:13312
    s_waitcnt lgkmcnt(4)
    s_waitcnt vmcnt(23)
    v_mfma_f32_32x32x16_bf16 v[32:47], v[24:27], v[116:119], v[32:47]
    v_mfma_f32_32x32x16_bf16 v[48:63], v[28:31], v[116:119], v[48:63]
    s_add_u32 s31, s61, 36864
    buffer_load_dwordx4 v[116:119], v1, s[12:15], s31 offen offset:1024 sc1
    ds_read_b64_tr_b16 v[24:25], v8 offset:14336
    ds_read_b64_tr_b16 v[26:27], v8 offset:15360
    ds_read_b64_tr_b16 v[28:29], v9 offset:14336
    ds_read_b64_tr_b16 v[30:31], v9 offset:15360
    s_waitcnt lgkmcnt(4)
    s_waitcnt vmcnt(23)
    v_mfma_f32_32x32x16_bf16 v[32:47], v[16:19], v[120:123], v[32:47]
    v_mfma_f32_32x32x16_bf16 v[48:63], v[20:23], v[120:123], v[48:63]
    s_add_u32 s31, s61, 36864
    buffer_load_dwordx4 v[120:123], v1, s[12:15], s31 offen offset:2048 sc1
    s_waitcnt lgkmcnt(0)
    s_waitcnt vmcnt(23)
    v_mfma_f32_32x32x16_bf16 v[32:47], v[24:27], v[124:127], v[32:47]
    v_mfma_f32_32x32x16_bf16 v[48:63], v[28:31], v[124:127], v[48:63]
    s_add_u32 s31, s61, 36864
    buffer_load_dwordx4 v[124:127], v1, s[12:15], s31 offen offset:3072 sc1
    v_add_u32 v8, 98304, v10
    v_add_u32 v9, 98304, v11
    ds_read_b64_tr_b16 v[16:17], v8 offset:0
    ds_read_b64_tr_b16 v[18:19], v8 offset:1024
    ds_read_b64_tr_b16 v[20:21], v9 offset:0
    ds_read_b64_tr_b16 v[22:23], v9 offset:1024
    ds_read_b64_tr_b16 v[24:25], v8 offset:2048
    ds_read_b64_tr_b16 v[26:27], v8 offset:3072
    ds_read_b64_tr_b16 v[28:29], v9 offset:2048
    ds_read_b64_tr_b16 v[30:31], v9 offset:3072
    s_waitcnt lgkmcnt(4)
    s_waitcnt vmcnt(23)
    v_mfma_f32_32x32x16_bf16 v[32:47], v[16:19], v[128:131], v[32:47]
    v_mfma_f32_32x32x16_bf16 v[48:63], v[20:23], v[128:131], v[48:63]
    s_add_u32 s31, s61, 40960
    buffer_load_dwordx4 v[128:131], v1, s[12:15], s31 offen offset:0 sc1
    ds_read_b64_tr_b16 v[16:17], v8 offset:4096
    ds_read_b64_tr_b16 v[18:19], v8 offset:5120
    ds_read_b64_tr_b16 v[20:21], v9 offset:4096
    ds_read_b64_tr_b16 v[22:23], v9 offset:5120
    s_waitcnt lgkmcnt(4)
    s_waitcnt vmcnt(23)
    v_mfma_f32_32x32x16_bf16 v[32:47], v[24:27], v[132:135], v[32:47]
    v_mfma_f32_32x32x16_bf16 v[48:63], v[28:31], v[132:135], v[48:63]
    s_add_u32 s31, s61, 40960
    buffer_load_dwordx4 v[132:135], v1, s[12:15], s31 offen offset:1024 sc1
    ds_read_b64_tr_b16 v[24:25], v8 offset:6144
    ds_read_b64_tr_b16 v[26:27], v8 offset:7168
    ds_read_b64_tr_b16 v[28:29], v9 offset:6144
    ds_read_b64_tr_b16 v[30:31], v9 offset:7168
    s_waitcnt lgkmcnt(4)
    s_waitcnt vmcnt(23)
    v_mfma_f32_32x32x16_bf16 v[32:47], v[16:19], v[136:139], v[32:47]
    v_mfma_f32_32x32x16_bf16 v[48:63], v[20:23], v[136:139], v[48:63]
    s_add_u32 s31, s61, 40960
    buffer_load_dwordx4 v[136:139], v1, s[12:15], s31 offen offset:2048 sc1
    ds_read_b64_tr_b16 v[16:17], v8 offset:8192
    ds_read_b64_tr_b16 v[18:19], v8 offset:9216
    ds_read_b64_tr_b16 v[20:21], v9 offset:8192
    ds_read_b64_tr_b16 v[22:23], v9 offset:9216
    s_waitcnt lgkmcnt(4)
    s_waitcnt vmcnt(23)
    v_mfma_f32_32x32x16_bf16 v[32:47], v[24:27], v[140:143], v[32:47]
    v_mfma_f32_32x32x16_bf16 v[48:63], v[28:31], v[140:143], v[48:63]
    s_add_u32 s31, s61, 40960
    buffer_load_dwordx4 v[140:143], v1, s[12:15], s31 offen offset:3072 sc1
    ds_read_b64_tr_b16 v[24:25], v8 offset:10240
    ds_read_b64_tr_b16 v[26:27], v8 offset:11264
    ds_read_b64_tr_b16 v[28:29], v9 offset:10240
    ds_read_b64_tr_b16 v[30:31], v9 offset:11264
    s_waitcnt lgkmcnt(4)
    s_waitcnt vmcnt(23)
    v_mfma_f32_32x32x16_bf16 v[32:47], v[16:19], v[144:147], v[32:47]
    v_mfma_f32_32x32x16_bf16 v[48:63], v[20:23], v[144:147], v[48:63]
    s_add_u32 s31, s61, 45056
    buffer_load_dwordx4 v[144:147], v1, s[12:15], s31 offen offset:0 sc1
    ds_read_b64_tr_b16 v[16:17], v8 offset:12288
    ds_read_b64_tr_b16 v[18:19], v8 offset:13312
    ds_read_b64_tr_b16 v[20:21], v9 offset:12288
    ds_read_b64_tr_b16 v[22:23], v9 offset:13312
    s_waitcnt lgkmcnt(4)
    s_waitcnt vmcnt(23)
    v_mfma_f32_32x32x16_bf16 v[32:47], v[24:27], v[148:151], v[32:47]
    v_mfma_f32_32x32x16_bf16 v[48:63], v[28:31], v[148:151], v[48:63]
    s_add_u32 s31, s61, 45056
    buffer_load_dwordx4 v[148:151], v1, s[12:15], s31 offen offset:1024 sc1
    ds_read_b64_tr_b16 v[24:25], v8 offset:14336
    ds_read_b64_tr_b16 v[26:27], v8 offset:15360
    ds_read_b64_tr_b16 v[28:29], v9 offset:14336
    ds_read_b64_tr_b16 v[30:31], v9 offset:15360
    s_waitcnt lgkmcnt(4)
    s_waitcnt vmcnt(23)
    v_mfma_f32_32x32x16_bf16 v[32:47], v[16:19], v[152:155], v[32:47]
    v_mfma_f32_32x32x16_bf16 v[48:63], v[20:23], v[152:155], v[48:63]
    s_add_u32 s31, s61, 45056
    buffer_load_dwordx4 v[152:155], v1, s[12:15], s31 offen offset:2048 sc1
    s_waitcnt lgkmcnt(0)
    s_waitcnt vmcnt(23)
    v_mfma_f32_32x32x16_bf16 v[32:47], v[24:27], v[156:159], v[32:47]
    v_mfma_f32_32x32x16_bf16 v[48:63], v[28:31], v[156:159], v[48:63]
    s_add_u32 s31, s61, 45056
    buffer_load_dwordx4 v[156:159], v1, s[12:15], s31 offen offset:3072 sc1
    v_add_u32 v8, 114688, v10
    v_add_u32 v9, 114688, v11
    ds_read_b64_tr_b16 v[16:17], v8 offset:0
    ds_read_b64_tr_b16 v[18:19], v8 offset:1024
    ds_read_b64_tr_b16 v[20:21], v9 offset:0
    ds_read_b64_tr_b16 v[22:23], v9 offset:1024
    ds_read_b64_tr_b16 v[24:25], v8 offset:2048
    ds_read_b64_tr_b16 v[26:27], v8 offset:3072
    ds_read_b64_tr_b16 v[28:29], v9 offset:2048
    ds_read_b64_tr_b16 v[30:31], v9 offset:3072
    s_waitcnt lgkmcnt(4)
    s_waitcnt vmcnt(23)
    v_mfma_f32_32x32x16_bf16 v[32:47], v[16:19], v[64:67], v[32:47]
    v_mfma_f32_32x32x16_bf16 v[48:63], v[20:23], v[64:67], v[48:63]
    s_add_u32 s31, s61, 49152
    buffer_load_dwordx4 v[64:67], v1, s[12:15], s31 offen offset:0 sc1
    ds_read_b64_tr_b16 v[16:17], v8 offset:4096
    ds_read_b64_tr_b16 v[18:19], v8 offset:5120
    ds_read_b64_tr_b16 v[20:21], v9 offset:4096
    ds_read_b64_tr_b16 v[22:23], v9 offset:5120
    s_waitcnt lgkmcnt(4)
    s_waitcnt vmcnt(23)
    v_mfma_f32_32x32x16_bf16 v[32:47], v[24:27], v[68:71], v[32:47]
    v_mfma_f32_32x32x16_bf16 v[48:63], v[28:31], v[68:71], v[48:63]
    s_add_u32 s31, s61, 49152
    buffer_load_dwordx4 v[68:71], v1, s[12:15], s31 offen offset:1024 sc1
    ds_read_b64_tr_b16 v[24:25], v8 offset:6144
    ds_read_b64_tr_b16 v[26:27], v8 offset:7168
    ds_read_b64_tr_b16 v[28:29], v9 offset:6144
    ds_read_b64_tr_b16 v[30:31], v9 offset:7168
    s_waitcnt lgkmcnt(4)
    s_waitcnt vmcnt(23)
    v_mfma_f32_32x32x16_bf16 v[32:47], v[16:19], v[72:75], v[32:47]
    v_mfma_f32_32x32x16_bf16 v[48:63], v[20:23], v[72:75], v[48:63]
    s_add_u32 s31, s61, 49152
    buffer_load_dwordx4 v[72:75], v1, s[12:15], s31 offen offset:2048 sc1
    ds_read_b64_tr_b16 v[16:17], v8 offset:8192
    ds_read_b64_tr_b16 v[18:19], v8 offset:9216
    ds_read_b64_tr_b16 v[20:21], v9 offset:8192
    ds_read_b64_tr_b16 v[22:23], v9 offset:9216
    s_waitcnt lgkmcnt(4)
    s_waitcnt vmcnt(23)
    v_mfma_f32_32x32x16_bf16 v[32:47], v[24:27], v[76:79], v[32:47]
    v_mfma_f32_32x32x16_bf16 v[48:63], v[28:31], v[76:79], v[48:63]
    s_add_u32 s31, s61, 49152
    buffer_load_dwordx4 v[76:79], v1, s[12:15], s31 offen offset:3072 sc1
    ds_read_b64_tr_b16 v[24:25], v8 offset:10240
    ds_read_b64_tr_b16 v[26:27], v8 offset:11264
    ds_read_b64_tr_b16 v[28:29], v9 offset:10240
    ds_read_b64_tr_b16 v[30:31], v9 offset:11264
    s_waitcnt lgkmcnt(4)
    s_waitcnt vmcnt(23)
    v_mfma_f32_32x32x16_bf16 v[32:47], v[16:19], v[80:83], v[32:47]
    v_mfma_f32_32x32x16_bf16 v[48:63], v[20:23], v[80:83], v[48:63]
    s_add_u32 s31, s61, 53248
    buffer_load_dwordx4 v[80:83], v1, s[12:15], s31 offen offset:0 sc1
    ds_read_b64_tr_b16 v[16:17], v8 offset:12288
    ds_read_b64_tr_b16 v[18:19], v8 offset:13312
    ds_read_b64_tr_b16 v[20:21], v9 offset:12288
    ds_read_b64_tr_b16 v[22:23], v9 offset:13312
    s_waitcnt lgkmcnt(4)
    s_waitcnt vmcnt(23)
    v_mfma_f32_32x32x16_bf16 v[32:47], v[24:27], v[84:87], v[32:47]
    v_mfma_f32_32x32x16_bf16 v[48:63], v[28:31], v[84:87], v[48:63]
    s_add_u32 s31, s61, 53248
    buffer_load_dwordx4 v[84:87], v1, s[12:15], s31 offen offset:1024 sc1
    ds_read_b64_tr_b16 v[24:25], v8 offset:14336
    ds_read_b64_tr_b16 v[26:27], v8 offset:15360
    ds_read_b64_tr_b16 v[28:29], v9 offset:14336
    ds_read_b64_tr_b16 v[30:31], v9 offset:15360
    s_waitcnt lgkmcnt(4)
    s_waitcnt vmcnt(23)
    v_mfma_f32_32x32x16_bf16 v[32:47], v[16:19], v[88:91], v[32:47]
    v_mfma_f32_32x32x16_bf16 v[48:63], v[20:23], v[88:91], v[48:63]
    s_add_u32 s31, s61, 53248
    buffer_load_dwordx4 v[88:91], v1, s[12:15], s31 offen offset:2048 sc1
    s_waitcnt lgkmcnt(0)
    s_waitcnt vmcnt(23)
    v_mfma_f32_32x32x16_bf16 v[32:47], v[24:27], v[92:95], v[32:47]
    v_mfma_f32_32x32x16_bf16 v[48:63], v[28:31], v[92:95], v[48:63]
    s_add_u32 s31, s61, 53248
    buffer_load_dwordx4 v[92:95], v1, s[12:15], s31 offen offset:3072 sc1
    v_add_u32 v8, 131072, v10
    v_add_u32 v9, 131072, v11
    ds_read_b64_tr_b16 v[16:17], v8 offset:0
    ds_read_b64_tr_b16 v[18:19], v8 offset:1024
    ds_read_b64_tr_b16 v[20:21], v9 offset:0
    ds_read_b64_tr_b16 v[22:23], v9 offset:1024
    ds_read_b64_tr_b16 v[24:25], v8 offset:2048
    ds_read_b64_tr_b16 v[26:27], v8 offset:3072
    ds_read_b64_tr_b16 v[28:29], v9 offset:2048
    ds_read_b64_tr_b16 v[30:31], v9 offset:3072
    s_waitcnt lgkmcnt(4)
    s_waitcnt vmcnt(23)
    v_mfma_f32_32x32x16_bf16 v[32:47], v[16:19], v[96:99], v[32:47]
    v_mfma_f32_32x32x16_bf16 v[48:63], v[20:23], v[96:99], v[48:63]
    s_add_u32 s31, s61, 57344
    buffer_load_dwordx4 v[96:99], v1, s[12:15], s31 offen offset:0 sc1
    ds_read_b64_tr_b16 v[16:17], v8 offset:4096
    ds_read_b64_tr_b16 v[18:19], v8 offset:5120
    ds_read_b64_tr_b16 v[20:21], v9 offset:4096
    ds_read_b64_tr_b16 v[22:23], v9 offset:5120
    s_waitcnt lgkmcnt(4)
    s_waitcnt vmcnt(23)
    v_mfma_f32_32x32x16_bf16 v[32:47], v[24:27], v[100:103], v[32:47]
    v_mfma_f32_32x32x16_bf16 v[48:63], v[28:31], v[100:103], v[48:63]
    s_add_u32 s31, s61, 57344
    buffer_load_dwordx4 v[100:103], v1, s[12:15], s31 offen offset:1024 sc1
    ds_read_b64_tr_b16 v[24:25], v8 offset:6144
    ds_read_b64_tr_b16 v[26:27], v8 offset:7168
    ds_read_b64_tr_b16 v[28:29], v9 offset:6144
    ds_read_b64_tr_b16 v[30:31], v9 offset:7168
    s_waitcnt lgkmcnt(4)
    s_waitcnt vmcnt(23)
    v_mfma_f32_32x32x16_bf16 v[32:47], v[16:19], v[104:107], v[32:47]
    v_mfma_f32_32x32x16_bf16 v[48:63], v[20:23], v[104:107], v[48:63]
    s_add_u32 s31, s61, 57344
    buffer_load_dwordx4 v[104:107], v1, s[12:15], s31 offen offset:2048 sc1
    ds_read_b64_tr_b16 v[16:17], v8 offset:8192
    ds_read_b64_tr_b16 v[18:19], v8 offset:9216
    ds_read_b64_tr_b16 v[20:21], v9 offset:8192
    ds_read_b64_tr_b16 v[22:23], v9 offset:9216
    s_waitcnt lgkmcnt(4)
    s_waitcnt vmcnt(23)
    v_mfma_f32_32x32x16_bf16 v[32:47], v[24:27], v[108:111], v[32:47]
    v_mfma_f32_32x32x16_bf16 v[48:63], v[28:31], v[108:111], v[48:63]
    s_add_u32 s31, s61, 57344
    buffer_load_dwordx4 v[108:111], v1, s[12:15], s31 offen offset:3072 sc1
    ds_read_b64_tr_b16 v[24:25], v8 offset:10240
    ds_read_b64_tr_b16 v[26:27], v8 offset:11264
    ds_read_b64_tr_b16 v[28:29], v9 offset:10240
    ds_read_b64_tr_b16 v[30:31], v9 offset:11264
    s_waitcnt lgkmcnt(4)
    s_waitcnt vmcnt(23)
    v_mfma_f32_32x32x16_bf16 v[32:47], v[16:19], v[112:115], v[32:47]
    v_mfma_f32_32x32x16_bf16 v[48:63], v[20:23], v[112:115], v[48:63]
    s_add_u32 s31, s61, 61440
    buffer_load_dwordx4 v[112:115], v1, s[12:15], s31 offen offset:0 sc1
    ds_read_b64_tr_b16 v[16:17], v8 offset:12288
    ds_read_b64_tr_b16 v[18:19], v8 offset:13312
    ds_read_b64_tr_b16 v[20:21], v9 offset:12288
    ds_read_b64_tr_b16 v[22:23], v9 offset:13312
    s_waitcnt lgkmcnt(4)
    s_waitcnt vmcnt(23)
    v_mfma_f32_32x32x16_bf16 v[32:47], v[24:27], v[116:119], v[32:47]
    v_mfma_f32_32x32x16_bf16 v[48:63], v[28:31], v[116:119], v[48:63]
    s_add_u32 s31, s61, 61440
    buffer_load_dwordx4 v[116:119], v1, s[12:15], s31 offen offset:1024 sc1
    ds_read_b64_tr_b16 v[24:25], v8 offset:14336
    ds_read_b64_tr_b16 v[26:27], v8 offset:15360
    ds_read_b64_tr_b16 v[28:29], v9 offset:14336
    ds_read_b64_tr_b16 v[30:31], v9 offset:15360
    s_waitcnt lgkmcnt(4)
    s_waitcnt vmcnt(23)
    v_mfma_f32_32x32x16_bf16 v[32:47], v[16:19], v[120:123], v[32:47]
    v_mfma_f32_32x32x16_bf16 v[48:63], v[20:23], v[120:123], v[48:63]
    s_add_u32 s31, s61, 61440
    buffer_load_dwordx4 v[120:123], v1, s[12:15], s31 offen offset:2048 sc1
    s_waitcnt lgkmcnt(0)
    s_waitcnt vmcnt(23)
    v_mfma_f32_32x32x16_bf16 v[32:47], v[24:27], v[124:127], v[32:47]
    v_mfma_f32_32x32x16_bf16 v[48:63], v[28:31], v[124:127], v[48:63]
    s_add_u32 s31, s61, 61440
    buffer_load_dwordx4 v[124:127], v1, s[12:15], s31 offen offset:3072 sc1
    v_add_u32 v8, 0, v10
    v_add_u32 v9, 0, v11
    ds_read_b64_tr_b16 v[16:17], v8 offset:0
    ds_read_b64_tr_b16 v[18:19], v8 offset:1024
    ds_read_b64_tr_b16 v[20:21], v9 offset:0
    ds_read_b64_tr_b16 v[22:23], v9 offset:1024
    ds_read_b64_tr_b16 v[24:25], v8 offset:2048
    ds_read_b64_tr_b16 v[26:27], v8 offset:3072
    ds_read_b64_tr_b16 v[28:29], v9 offset:2048
    ds_read_b64_tr_b16 v[30:31], v9 offset:3072
    s_waitcnt lgkmcnt(4)
    s_waitcnt vmcnt(23)
    v_mfma_f32_32x32x16_bf16 v[32:47], v[16:19], v[128:131], v[32:47]
    v_mfma_f32_32x32x16_bf16 v[48:63], v[20:23], v[128:131], v[48:63]
    ds_read_b64_tr_b16 v[16:17], v8 offset:4096
    ds_read_b64_tr_b16 v[18:19], v8 offset:5120
    ds_read_b64_tr_b16 v[20:21], v9 offset:4096
    ds_read_b64_tr_b16 v[22:23], v9 offset:5120
    s_waitcnt lgkmcnt(4)
    s_waitcnt vmcnt(22)
    v_mfma_f32_32x32x16_bf16 v[32:47], v[24:27], v[132:135], v[32:47]
    v_mfma_f32_32x32x16_bf16 v[48:63], v[28:31], v[132:135], v[48:63]
    ds_read_b64_tr_b16 v[24:25], v8 offset:6144
    ds_read_b64_tr_b16 v[26:27], v8 offset:7168
    ds_read_b64_tr_b16 v[28:29], v9 offset:6144
    ds_read_b64_tr_b16 v[30:31], v9 offset:7168
    s_waitcnt lgkmcnt(4)
    s_waitcnt vmcnt(21)
    v_mfma_f32_32x32x16_bf16 v[32:47], v[16:19], v[136:139], v[32:47]
    v_mfma_f32_32x32x16_bf16 v[48:63], v[20:23], v[136:139], v[48:63]
    ds_read_b64_tr_b16 v[16:17], v8 offset:8192
    ds_read_b64_tr_b16 v[18:19], v8 offset:9216
    ds_read_b64_tr_b16 v[20:21], v9 offset:8192
    ds_read_b64_tr_b16 v[22:23], v9 offset:9216
    s_waitcnt lgkmcnt(4)
    s_waitcnt vmcnt(20)
    v_mfma_f32_32x32x16_bf16 v[32:47], v[24:27], v[140:143], v[32:47]
    v_mfma_f32_32x32x16_bf16 v[48:63], v[28:31], v[140:143], v[48:63]
    ds_read_b64_tr_b16 v[24:25], v8 offset:10240
    ds_read_b64_tr_b16 v[26:27], v8 offset:11264
    ds_read_b64_tr_b16 v[28:29], v9 offset:10240
    ds_read_b64_tr_b16 v[30:31], v9 offset:11264
    s_waitcnt lgkmcnt(4)
    s_waitcnt vmcnt(19)
    v_mfma_f32_32x32x16_bf16 v[32:47], v[16:19], v[144:147], v[32:47]
    v_mfma_f32_32x32x16_bf16 v[48:63], v[20:23], v[144:147], v[48:63]
    ds_read_b64_tr_b16 v[16:17], v8 offset:12288
    ds_read_b64_tr_b16 v[18:19], v8 offset:13312
    ds_read_b64_tr_b16 v[20:21], v9 offset:12288
    ds_read_b64_tr_b16 v[22:23], v9 offset:13312
    s_waitcnt lgkmcnt(4)
    s_waitcnt vmcnt(18)
    v_mfma_f32_32x32x16_bf16 v[32:47], v[24:27], v[148:151], v[32:47]
    v_mfma_f32_32x32x16_bf16 v[48:63], v[28:31], v[148:151], v[48:63]
    ds_read_b64_tr_b16 v[24:25], v8 offset:14336
    ds_read_b64_tr_b16 v[26:27], v8 offset:15360
    ds_read_b64_tr_b16 v[28:29], v9 offset:14336
    ds_read_b64_tr_b16 v[30:31], v9 offset:15360
    s_waitcnt lgkmcnt(4)
    s_waitcnt vmcnt(17)
    v_mfma_f32_32x32x16_bf16 v[32:47], v[16:19], v[152:155], v[32:47]
    v_mfma_f32_32x32x16_bf16 v[48:63], v[20:23], v[152:155], v[48:63]
    s_waitcnt lgkmcnt(0)
    s_waitcnt vmcnt(16)
    v_mfma_f32_32x32x16_bf16 v[32:47], v[24:27], v[156:159], v[32:47]
    v_mfma_f32_32x32x16_bf16 v[48:63], v[28:31], v[156:159], v[48:63]
    v_add_u32 v8, 16384, v10
    v_add_u32 v9, 16384, v11
    ds_read_b64_tr_b16 v[16:17], v8 offset:0
    ds_read_b64_tr_b16 v[18:19], v8 offset:1024
    ds_read_b64_tr_b16 v[20:21], v9 offset:0
    ds_read_b64_tr_b16 v[22:23], v9 offset:1024
    ds_read_b64_tr_b16 v[24:25], v8 offset:2048
    ds_read_b64_tr_b16 v[26:27], v8 offset:3072
    ds_read_b64_tr_b16 v[28:29], v9 offset:2048
    ds_read_b64_tr_b16 v[30:31], v9 offset:3072
    s_waitcnt lgkmcnt(4)
    s_waitcnt vmcnt(15)
    v_mfma_f32_32x32x16_bf16 v[32:47], v[16:19], v[64:67], v[32:47]
    v_mfma_f32_32x32x16_bf16 v[48:63], v[20:23], v[64:67], v[48:63]
    ds_read_b64_tr_b16 v[16:17], v8 offset:4096
    ds_read_b64_tr_b16 v[18:19], v8 offset:5120
    ds_read_b64_tr_b16 v[20:21], v9 offset:4096
    ds_read_b64_tr_b16 v[22:23], v9 offset:5120
    s_waitcnt lgkmcnt(4)
    s_waitcnt vmcnt(14)
    v_mfma_f32_32x32x16_bf16 v[32:47], v[24:27], v[68:71], v[32:47]
    v_mfma_f32_32x32x16_bf16 v[48:63], v[28:31], v[68:71], v[48:63]
    ds_read_b64_tr_b16 v[24:25], v8 offset:6144
    ds_read_b64_tr_b16 v[26:27], v8 offset:7168
    ds_read_b64_tr_b16 v[28:29], v9 offset:6144
    ds_read_b64_tr_b16 v[30:31], v9 offset:7168
    s_waitcnt lgkmcnt(4)
    s_waitcnt vmcnt(13)
    v_mfma_f32_32x32x16_bf16 v[32:47], v[16:19], v[72:75], v[32:47]
    v_mfma_f32_32x32x16_bf16 v[48:63], v[20:23], v[72:75], v[48:63]
    ds_read_b64_tr_b16 v[16:17], v8 offset:8192
    ds_read_b64_tr_b16 v[18:19], v8 offset:9216
    ds_read_b64_tr_b16 v[20:21], v9 offset:8192
    ds_read_b64_tr_b16 v[22:23], v9 offset:9216
    s_waitcnt lgkmcnt(4)
    s_waitcnt vmcnt(12)
    v_mfma_f32_32x32x16_bf16 v[32:47], v[24:27], v[76:79], v[32:47]
    v_mfma_f32_32x32x16_bf16 v[48:63], v[28:31], v[76:79], v[48:63]
    ds_read_b64_tr_b16 v[24:25], v8 offset:10240
    ds_read_b64_tr_b16 v[26:27], v8 offset:11264
    ds_read_b64_tr_b16 v[28:29], v9 offset:10240
    ds_read_b64_tr_b16 v[30:31], v9 offset:11264
    s_waitcnt lgkmcnt(4)
    s_waitcnt vmcnt(11)
    v_mfma_f32_32x32x16_bf16 v[32:47], v[16:19], v[80:83], v[32:47]
    v_mfma_f32_32x32x16_bf16 v[48:63], v[20:23], v[80:83], v[48:63]
    ds_read_b64_tr_b16 v[16:17], v8 offset:12288
    ds_read_b64_tr_b16 v[18:19], v8 offset:13312
    ds_read_b64_tr_b16 v[20:21], v9 offset:12288
    ds_read_b64_tr_b16 v[22:23], v9 offset:13312
    s_waitcnt lgkmcnt(4)
    s_waitcnt vmcnt(10)
    v_mfma_f32_32x32x16_bf16 v[32:47], v[24:27], v[84:87], v[32:47]
    v_mfma_f32_32x32x16_bf16 v[48:63], v[28:31], v[84:87], v[48:63]
    ds_read_b64_tr_b16 v[24:25], v8 offset:14336
    ds_read_b64_tr_b16 v[26:27], v8 offset:15360
    ds_read_b64_tr_b16 v[28:29], v9 offset:14336
    ds_read_b64_tr_b16 v[30:31], v9 offset:15360
    s_waitcnt lgkmcnt(4)
    s_waitcnt vmcnt(9)
    v_mfma_f32_32x32x16_bf16 v[32:47], v[16:19], v[88:91], v[32:47]
    v_mfma_f32_32x32x16_bf16 v[48:63], v[20:23], v[88:91], v[48:63]
    s_waitcnt lgkmcnt(0)
    s_waitcnt vmcnt(8)
    v_mfma_f32_32x32x16_bf16 v[32:47], v[24:27], v[92:95], v[32:47]
    v_mfma_f32_32x32x16_bf16 v[48:63], v[28:31], v[92:95], v[48:63]
    v_add_u32 v8, 32768, v10
    v_add_u32 v9, 32768, v11
    ds_read_b64_tr_b16 v[16:17], v8 offset:0
    ds_read_b64_tr_b16 v[18:19], v8 offset:1024
    ds_read_b64_tr_b16 v[20:21], v9 offset:0
    ds_read_b64_tr_b16 v[22:23], v9 offset:1024
    ds_read_b64_tr_b16 v[24:25], v8 offset:2048
    ds_read_b64_tr_b16 v[26:27], v8 offset:3072
    ds_read_b64_tr_b16 v[28:29], v9 offset:2048
    ds_read_b64_tr_b16 v[30:31], v9 offset:3072
    s_waitcnt lgkmcnt(4)
    s_waitcnt vmcnt(7)
    v_mfma_f32_32x32x16_bf16 v[32:47], v[16:19], v[96:99], v[32:47]
    v_mfma_f32_32x32x16_bf16 v[48:63], v[20:23], v[96:99], v[48:63]
    ds_read_b64_tr_b16 v[16:17], v8 offset:4096
    ds_read_b64_tr_b16 v[18:19], v8 offset:5120
    ds_read_b64_tr_b16 v[20:21], v9 offset:4096
    ds_read_b64_tr_b16 v[22:23], v9 offset:5120
    s_waitcnt lgkmcnt(4)
    s_waitcnt vmcnt(6)
    v_mfma_f32_32x32x16_bf16 v[32:47], v[24:27], v[100:103], v[32:47]
    v_mfma_f32_32x32x16_bf16 v[48:63], v[28:31], v[100:103], v[48:63]
    ds_read_b64_tr_b16 v[24:25], v8 offset:6144
    ds_read_b64_tr_b16 v[26:27], v8 offset:7168
    ds_read_b64_tr_b16 v[28:29], v9 offset:6144
    ds_read_b64_tr_b16 v[30:31], v9 offset:7168
    s_waitcnt lgkmcnt(4)
    s_waitcnt vmcnt(5)
    v_mfma_f32_32x32x16_bf16 v[32:47], v[16:19], v[104:107], v[32:47]
    v_mfma_f32_32x32x16_bf16 v[48:63], v[20:23], v[104:107], v[48:63]
    ds_read_b64_tr_b16 v[16:17], v8 offset:8192
    ds_read_b64_tr_b16 v[18:19], v8 offset:9216
    ds_read_b64_tr_b16 v[20:21], v9 offset:8192
    ds_read_b64_tr_b16 v[22:23], v9 offset:9216
    s_waitcnt lgkmcnt(4)
    s_waitcnt vmcnt(4)
    v_mfma_f32_32x32x16_bf16 v[32:47], v[24:27], v[108:111], v[32:47]
    v_mfma_f32_32x32x16_bf16 v[48:63], v[28:31], v[108:111], v[48:63]
    ds_read_b64_tr_b16 v[24:25], v8 offset:10240
    ds_read_b64_tr_b16 v[26:27], v8 offset:11264
    ds_read_b64_tr_b16 v[28:29], v9 offset:10240
    ds_read_b64_tr_b16 v[30:31], v9 offset:11264
    s_waitcnt lgkmcnt(4)
    s_waitcnt vmcnt(3)
    v_mfma_f32_32x32x16_bf16 v[32:47], v[16:19], v[112:115], v[32:47]
    v_mfma_f32_32x32x16_bf16 v[48:63], v[20:23], v[112:115], v[48:63]
    ds_read_b64_tr_b16 v[16:17], v8 offset:12288
    ds_read_b64_tr_b16 v[18:19], v8 offset:13312
    ds_read_b64_tr_b16 v[20:21], v9 offset:12288
    ds_read_b64_tr_b16 v[22:23], v9 offset:13312
    s_waitcnt lgkmcnt(4)
    s_waitcnt vmcnt(2)
    v_mfma_f32_32x32x16_bf16 v[32:47], v[24:27], v[116:119], v[32:47]
    v_mfma_f32_32x32x16_bf16 v[48:63], v[28:31], v[116:119], v[48:63]
    ds_read_b64_tr_b16 v[24:25], v8 offset:14336
    ds_read_b64_tr_b16 v[26:27], v8 offset:15360
    ds_read_b64_tr_b16 v[28:29], v9 offset:14336
    ds_read_b64_tr_b16 v[30:31], v9 offset:15360
    s_waitcnt lgkmcnt(4)
    s_waitcnt vmcnt(1)
    v_mfma_f32_32x32x16_bf16 v[32:47], v[16:19], v[120:123], v[32:47]
    v_mfma_f32_32x32x16_bf16 v[48:63], v[20:23], v[120:123], v[48:63]
    s_waitcnt lgkmcnt(0)
    s_waitcnt vmcnt(0)
    v_mfma_f32_32x32x16_bf16 v[32:47], v[24:27], v[124:127], v[32:47]
    v_mfma_f32_32x32x16_bf16 v[48:63], v[28:31], v[124:127], v[48:63]
    s_nop 15
    v_and_b32 v2, 31, v0
    v_lshlrev_b32 v2, 12, v2
    v_lshl_add_u32 v2, v5, 4, v2
    s_lshl_b32 s62, s60, 17
    s_lshl_b32 s63, s4, 7
    s_add_u32 s62, s62, s63
    s_add_u32 s62, s62, 2048
    v_cvt_pk_bf16_f32 v64, v32, v33
    v_cvt_pk_bf16_f32 v65, v34, v35
    v_cvt_pk_bf16_f32 v66, v36, v37
    v_cvt_pk_bf16_f32 v67, v38, v39
    s_nop 1
    v_permlane32_swap_b32 v64, v66
    v_permlane32_swap_b32 v65, v67
    s_nop 1
    buffer_store_dwordx4 v[64:67], v2, s[36:39], s62 offen offset:0
    v_cvt_pk_bf16_f32 v68, v40, v41
    v_cvt_pk_bf16_f32 v69, v42, v43
    v_cvt_pk_bf16_f32 v70, v44, v45
    v_cvt_pk_bf16_f32 v71, v46, v47
    s_nop 1
    v_permlane32_swap_b32 v68, v70
    v_permlane32_swap_b32 v69, v71
    s_nop 1
    buffer_store_dwordx4 v[68:71], v2, s[36:39], s62 offen offset:32
    v_cvt_pk_bf16_f32 v72, v48, v49
    v_cvt_pk_bf16_f32 v73, v50, v51
    v_cvt_pk_bf16_f32 v74, v52, v53
    v_cvt_pk_bf16_f32 v75, v54, v55
    s_nop 1
    v_permlane32_swap_b32 v72, v74
    v_permlane32_swap_b32 v73, v75
    s_nop 1
    buffer_store_dwordx4 v[72:75], v2, s[36:39], s62 offen offset:64
    v_cvt_pk_bf16_f32 v76, v56, v57
    v_cvt_pk_bf16_f32 v77, v58, v59
    v_cvt_pk_bf16_f32 v78, v60, v61
    v_cvt_pk_bf16_f32 v79, v62, v63
    s_nop 1
    v_permlane32_swap_b32 v76, v78
    v_permlane32_swap_b32 v77, v79
    s_nop 1
    buffer_store_dwordx4 v[76:79], v2, s[36:39], s62 offen offset:96
    s_endpgm
L_roleH_5:
    s_sub_u32 s28, s28, 8
    s_lshr_b32 s80, s2, 4
    s_lshl_b32 s80, s80, 2
    s_add_u32 s80, s80, s28
    s_and_b32 s81, s2, 15
    s_lshl_b32 s82, s80, 5
    s_lshl_b32 s83, s81, 6
    v_lshrrev_b32 v11, 3, v0
    v_and_b32 v12, 7, v0
    s_lshl_b32 s84, s83, 3
    v_lshlrev_b32 v13, 6, v12
    s_barrier
    buffer_load_dwordx4 v[140:143], v13, s[56:59], s84 offen offset:0
    buffer_load_dwordx4 v[144:147], v13, s[56:59], s84 offen offset:16
    buffer_load_dwordx4 v[148:151], v13, s[56:59], s84 offen offset:32
    buffer_load_dwordx4 v[152:155], v13, s[56:59], s84 offen offset:48
    s_lshl_b32 s84, s82, 11
    s_lshl_b32 s85, s83, 1
    s_add_u32 s84, s84, s85
    v_lshlrev_b32 v13, 13, v11
    v_lshl_add_u32 v13, v12, 4, v13
    v_add_u32 v13, s84, v13
    v_subrev_u32 v8, 6144, v13
    v_subrev_u32 v9, 4096, v13
    v_subrev_u32 v10, 2048, v13
    buffer_load_dwordx4 v[64:67], v8, s[48:51], 0 offen
    buffer_load_dwordx4 v[68:71], v9, s[48:51], 0 offen
    buffer_load_dwordx4 v[72:75], v10, s[48:51], 0 offen
    s_mov_b32 s84, 0
    buffer_load_dwordx4 v[76:79], v13, s[48:51], s84 offen
    buffer_load_dwordx4 v[92:95], v13, s[52:55], s84 offen
    s_mov_b32 s84, 2048
    buffer_load_dwordx4 v[80:83], v13, s[48:51], s84 offen
    buffer_load_dwordx4 v[96:99], v13, s[52:55], s84 offen
    s_mov_b32 s84, 4096
    buffer_load_dwordx4 v[84:87], v13, s[48:51], s84 offen
    buffer_load_dwordx4 v[100:103], v13, s[52:55], s84 offen
    s_mov_b32 s84, 6144
    buffer_load_dwordx4 v[88:91], v13, s[48:51], s84 offen
    buffer_load_dwordx4 v[104:107], v13, s[52:55], s84 offen
    s_lshl_b32 s86, s28, 12
    s_add_u32 s86, s86, 147456
    v_lshlrev_b32 v14, 9, v11
    v_lshl_add_u32 v14, v12, 4, v14
    v_add_u32 v14, s86, v14
    v_lshrrev_b32 v11, 4, v0
    v_and_b32 v12, 15, v0
    v_lshrrev_b32 v15, 2, v12
    v_and_b32 v4, 3, v12
    v_lshlrev_b32 v2, 3, v11
    v_add_u32 v2, 3, v2
    v_sub_u32 v2, v2, v15
    v_lshlrev_b32 v2, 7, v2
    v_lshl_add_u32 v2, v4, 3, v2
    v_add_u32 v2, s86, v2
    v_add_u32 v3, s83, v12
    v_mul_u32_u24 v3, 4224, v3
    s_lshl_b32 s85, s82, 1
    s_sub_u32 s85, 4080, s85
    v_add_u32 v3, s85, v3
    v_lshlrev_b32 v4, 4, v11
    v_sub_u32 v3, v3, v4
    s_barrier
    s_barrier
    s_barrier
    s_waitcnt vmcnt(0)
    v_lshlrev_b32 v32, 16, v140
    v_and_b32 v33, 0xffff0000, v140
    v_lshlrev_b32 v34, 16, v141
    v_and_b32 v35, 0xffff0000, v141
    v_lshlrev_b32 v36, 16, v142
    v_and_b32 v37, 0xffff0000, v142
    v_lshlrev_b32 v38, 16, v143
    v_and_b32 v39, 0xffff0000, v143
    v_lshlrev_b32 v40, 16, v144
    v_and_b32 v41, 0xffff0000, v144
    v_lshlrev_b32 v42, 16, v145
    v_and_b32 v43, 0xffff0000, v145
    v_lshlrev_b32 v44, 16, v146
    v_and_b32 v45, 0xffff0000, v146
    v_lshlrev_b32 v46, 16, v147
    v_and_b32 v47, 0xffff0000, v147
    v_lshlrev_b32 v48, 16, v148
    v_and_b32 v49, 0xffff0000, v148
    v_lshlrev_b32 v50, 16, v149
    v_and_b32 v51, 0xffff0000, v149
    v_lshlrev_b32 v52, 16, v150
    v_and_b32 v53, 0xffff0000, v150
    v_lshlrev_b32 v54, 16, v151
    v_and_b32 v55, 0xffff0000, v151
    v_lshlrev_b32 v56, 16, v152
    v_and_b32 v57, 0xffff0000, v152
    v_lshlrev_b32 v58, 16, v153
    v_and_b32 v59, 0xffff0000, v153
    v_lshlrev_b32 v60, 16, v154
    v_and_b32 v61, 0xffff0000, v154
    v_lshlrev_b32 v62, 16, v155
    v_and_b32 v63, 0xffff0000, v155
    v_lshlrev_b32 v108, 16, v64
    v_and_b32 v109, 0xffff0000, v64
    v_lshlrev_b32 v110, 16, v65
    v_and_b32 v111, 0xffff0000, v65
    v_lshlrev_b32 v112, 16, v66
    v_and_b32 v113, 0xffff0000, v66
    v_lshlrev_b32 v114, 16, v67
    v_and_b32 v115, 0xffff0000, v67
    v_lshlrev_b32 v116, 16, v68
    v_and_b32 v117, 0xffff0000, v68
    v_lshlrev_b32 v118, 16, v69
    v_and_b32 v119, 0xffff0000, v69
    v_lshlrev_b32 v120, 16, v70
    v_and_b32 v121, 0xffff0000, v70
    v_lshlrev_b32 v122, 16, v71
    v_and_b32 v123, 0xffff0000, v71
    v_lshlrev_b32 v124, 16, v72
    v_and_b32 v125, 0xffff0000, v72
    v_lshlrev_b32 v126, 16, v73
    v_and_b32 v127, 0xffff0000, v73
    v_lshlrev_b32 v128, 16, v74
    v_and_b32 v129, 0xffff0000, v74
    v_lshlrev_b32 v130, 16, v75
    v_and_b32 v131, 0xffff0000, v75
    v_lshlrev_b32 v132, 16, v76
    v_and_b32 v133, 0xffff0000, v76
    v_lshlrev_b32 v134, 16, v77
    v_and_b32 v135, 0xffff0000, v77
    v_lshlrev_b32 v136, 16, v78
    v_and_b32 v137, 0xffff0000, v78
    v_lshlrev_b32 v138, 16, v79
    v_and_b32 v139, 0xffff0000, v79
    v_lshlrev_b32 v24, 16, v92
    v_and_b32 v25, 0xffff0000, v92
    v_lshlrev_b32 v26, 16, v93
    v_and_b32 v27, 0xffff0000, v93
    v_lshlrev_b32 v28, 16, v94
    v_and_b32 v29, 0xffff0000, v94
    v_lshlrev_b32 v30, 16, v95
    v_and_b32 v31, 0xffff0000, v95
    v_mul_f32 v16, v108, v35
    v_mul_f32 v17, v109, v39
    v_mul_f32 v18, v110, v43
    v_mul_f32 v19, v111, v47
    v_mul_f32 v20, v112, v51
    v_mul_f32 v21, v113, v55
    v_mul_f32 v22, v114, v59
    v_mul_f32 v23, v115, v63
    v_fmac_f32 v16, v116, v34
    v_fmac_f32 v17, v117, v38
    v_fmac_f32 v18, v118, v42
    v_fmac_f32 v19, v119, v46
    v_fmac_f32 v20, v120, v50
    v_fmac_f32 v21, v121, v54
    v_fmac_f32 v22, v122, v58
    v_fmac_f32 v23, v123, v62
    v_fmac_f32 v16, v124, v33
    v_fmac_f32 v17, v125, v37
    v_fmac_f32 v18, v126, v41
    v_fmac_f32 v19, v127, v45
    v_fmac_f32 v20, v128, v49
    v_fmac_f32 v21, v129, v53
    v_fmac_f32 v22, v130, v57
    v_fmac_f32 v23, v131, v61
    v_fmac_f32 v16, v132, v32
    v_fmac_f32 v17, v133, v36
    v_fmac_f32 v18, v134, v40
    v_fmac_f32 v19, v135, v44
    v_fmac_f32 v20, v136, v48
    v_fmac_f32 v21, v137, v52
    v_fmac_f32 v22, v138, v56
    v_fmac_f32 v23, v139, v60
    v_mul_f32 v16, v16, v24
    v_mul_f32 v17, v17, v25
    v_mul_f32 v18, v18, v26
    v_mul_f32 v19, v19, v27
    v_mul_f32 v20, v20, v28
    v_mul_f32 v21, v21, v29
    v_mul_f32 v22, v22, v30
    v_mul_f32 v23, v23, v31
    v_cvt_pk_bf16_f32 v92, v16, v17
    v_cvt_pk_bf16_f32 v93, v18, v19
    v_cvt_pk_bf16_f32 v94, v20, v21
    v_cvt_pk_bf16_f32 v95, v22, v23
    v_lshlrev_b32 v108, 16, v80
    v_and_b32 v109, 0xffff0000, v80
    v_lshlrev_b32 v110, 16, v81
    v_and_b32 v111, 0xffff0000, v81
    v_lshlrev_b32 v112, 16, v82
    v_and_b32 v113, 0xffff0000, v82
    v_lshlrev_b32 v114, 16, v83
    v_and_b32 v115, 0xffff0000, v83
    v_lshlrev_b32 v24, 16, v96
    v_and_b32 v25, 0xffff0000, v96
    v_lshlrev_b32 v26, 16, v97
    v_and_b32 v27, 0xffff0000, v97
    v_lshlrev_b32 v28, 16, v98
    v_and_b32 v29, 0xffff0000, v98
    v_lshlrev_b32 v30, 16, v99
    v_and_b32 v31, 0xffff0000, v99
    v_mul_f32 v16, v116, v35
    v_mul_f32 v17, v117, v39
    v_mul_f32 v18, v118, v43
    v_mul_f32 v19, v119, v47
    v_mul_f32 v20, v120, v51
    v_mul_f32 v21, v121, v55
    v_mul_f32 v22, v122, v59
    v_mul_f32 v23, v123, v63
    v_fmac_f32 v16, v124, v34
    v_fmac_f32 v17, v125, v38
    v_fmac_f32 v18, v126, v42
    v_fmac_f32 v19, v127, v46
    v_fmac_f32 v20, v128, v50
    v_fmac_f32 v21, v129, v54
    v_fmac_f32 v22, v130, v58
    v_fmac_f32 v23, v131, v62
    v_fmac_f32 v16, v132, v33
    v_fmac_f32 v17, v133, v37
    v_fmac_f32 v18, v134, v41
    v_fmac_f32 v19, v135, v45
    v_fmac_f32 v20, v136, v49
    v_fmac_f32 v21, v137, v53
    v_fmac_f32 v22, v138, v57
    v_fmac_f32 v23, v139, v61
    v_fmac_f32 v16, v108, v32
    v_fmac_f32 v17, v109, v36
    v_fmac_f32 v18, v110, v40
    v_fmac_f32 v19, v111, v44
    v_fmac_f32 v20, v112, v48
    v_fmac_f32 v21, v113, v52
    v_fmac_f32 v22, v114, v56
    v_fmac_f32 v23, v115, v60
    v_mul_f32 v16, v16, v24
    v_mul_f32 v17, v17, v25
    v_mul_f32 v18, v18, v26
    v_mul_f32 v19, v19, v27
    v_mul_f32 v20, v20, v28
    v_mul_f32 v21, v21, v29
    v_mul_f32 v22, v22, v30
    v_mul_f32 v23, v23, v31
    v_cvt_pk_bf16_f32 v96, v16, v17
    v_cvt_pk_bf16_f32 v97, v18, v19
    v_cvt_pk_bf16_f32 v98, v20, v21
    v_cvt_pk_bf16_f32 v99, v22, v23
    s_barrier
    v_lshlrev_b32 v116, 16, v84
    v_and_b32 v117, 0xffff0000, v84
    v_lshlrev_b32 v118, 16, v85
    v_and_b32 v119, 0xffff0000, v85
    v_lshlrev_b32 v120, 16, v86
    v_and_b32 v121, 0xffff0000, v86
    v_lshlrev_b32 v122, 16, v87
    v_and_b32 v123, 0xffff0000, v87
    v_lshlrev_b32 v24, 16, v100
    v_and_b32 v25, 0xffff0000, v100
    v_lshlrev_b32 v26, 16, v101
    v_and_b32 v27, 0xffff0000, v101
    v_lshlrev_b32 v28, 16, v102
    v_and_b32 v29, 0xffff0000, v102
    v_lshlrev_b32 v30, 16, v103
    v_and_b32 v31, 0xffff0000, v103
    v_mul_f32 v16, v124, v35
    v_mul_f32 v17, v125, v39
    v_mul_f32 v18, v126, v43
    v_mul_f32 v19, v127, v47
    v_mul_f32 v20, v128, v51
    v_mul_f32 v21, v129, v55
    v_mul_f32 v22, v130, v59
    v_mul_f32 v23, v131, v63
    v_fmac_f32 v16, v132, v34
    v_fmac_f32 v17, v133, v38
    v_fmac_f32 v18, v134, v42
    v_fmac_f32 v19, v135, v46
    v_fmac_f32 v20, v136, v50
    v_fmac_f32 v21, v137, v54
    v_fmac_f32 v22, v138, v58
    v_fmac_f32 v23, v139, v62
    v_fmac_f32 v16, v108, v33
    v_fmac_f32 v17, v109, v37
    v_fmac_f32 v18, v110, v41
    v_fmac_f32 v19, v111, v45
    v_fmac_f32 v20, v112, v49
    v_fmac_f32 v21, v113, v53
    v_fmac_f32 v22, v114, v57
    v_fmac_f32 v23, v115, v61
    v_fmac_f32 v16, v116, v32
    v_fmac_f32 v17, v117, v36
    v_fmac_f32 v18, v118, v40
    v_fmac_f32 v19, v119, v44
    v_fmac_f32 v20, v120, v48
    v_fmac_f32 v21, v121, v52
    v_fmac_f32 v22, v122, v56
    v_fmac_f32 v23, v123, v60
    v_mul_f32 v16, v16, v24
    v_mul_f32 v17, v17, v25
    v_mul_f32 v18, v18, v26
    v_mul_f32 v19, v19, v27
    v_mul_f32 v20, v20, v28
    v_mul_f32 v21, v21, v29
    v_mul_f32 v22, v22, v30
    v_mul_f32 v23, v23, v31
    v_cvt_pk_bf16_f32 v100, v16, v17
    v_cvt_pk_bf16_f32 v101, v18, v19
    v_cvt_pk_bf16_f32 v102, v20, v21
    v_cvt_pk_bf16_f32 v103, v22, v23
    v_lshlrev_b32 v124, 16, v88
    v_and_b32 v125, 0xffff0000, v88
    v_lshlrev_b32 v126, 16, v89
    v_and_b32 v127, 0xffff0000, v89
    v_lshlrev_b32 v128, 16, v90
    v_and_b32 v129, 0xffff0000, v90
    v_lshlrev_b32 v130, 16, v91
    v_and_b32 v131, 0xffff0000, v91
    v_lshlrev_b32 v24, 16, v104
    v_and_b32 v25, 0xffff0000, v104
    v_lshlrev_b32 v26, 16, v105
    v_and_b32 v27, 0xffff0000, v105
    v_lshlrev_b32 v28, 16, v106
    v_and_b32 v29, 0xffff0000, v106
    v_lshlrev_b32 v30, 16, v107
    v_and_b32 v31, 0xffff0000, v107
    v_mul_f32 v16, v132, v35
    v_mul_f32 v17, v133, v39
    v_mul_f32 v18, v134, v43
    v_mul_f32 v19, v135, v47
    v_mul_f32 v20, v136, v51
    v_mul_f32 v21, v137, v55
    v_mul_f32 v22, v138, v59
    v_mul_f32 v23, v139, v63
    v_fmac_f32 v16, v108, v34
    v_fmac_f32 v17, v109, v38
    v_fmac_f32 v18, v110, v42
    v_fmac_f32 v19, v111, v46
    v_fmac_f32 v20, v112, v50
    v_fmac_f32 v21, v113, v54
    v_fmac_f32 v22, v114, v58
    v_fmac_f32 v23, v115, v62
    v_fmac_f32 v16, v116, v33
    v_fmac_f32 v17, v117, v37
    v_fmac_f32 v18, v118, v41
    v_fmac_f32 v19, v119, v45
    v_fmac_f32 v20, v120, v49
    v_fmac_f32 v21, v121, v53
    v_fmac_f32 v22, v122, v57
    v_fmac_f32 v23, v123, v61
    v_fmac_f32 v16, v124, v32
    v_fmac_f32 v17, v125, v36
    v_fmac_f32 v18, v126, v40
    v_fmac_f32 v19, v127, v44
    v_fmac_f32 v20, v128, v48
    v_fmac_f32 v21, v129, v52
    v_fmac_f32 v22, v130, v56
    v_fmac_f32 v23, v131, v60
    v_mul_f32 v16, v16, v24
    v_mul_f32 v17, v17, v25
    v_mul_f32 v18, v18, v26
    v_mul_f32 v19, v19, v27
    v_mul_f32 v20, v20, v28
    v_mul_f32 v21, v21, v29
    v_mul_f32 v22, v22, v30
    v_mul_f32 v23, v23, v31
    v_cvt_pk_bf16_f32 v104, v16, v17
    v_cvt_pk_bf16_f32 v105, v18, v19
    v_cvt_pk_bf16_f32 v106, v20, v21
    v_cvt_pk_bf16_f32 v107, v22, v23
    s_barrier
    ds_write_b128 v14, v[92:95] offset:0
    ds_write_b128 v14, v[96:99] offset:128
    ds_write_b128 v14, v[100:103] offset:256
    ds_write_b128 v14, v[104:107] offset:384
    s_waitcnt lgkmcnt(0)
    ds_read_b64_tr_b16 v[64:65], v2 offset:512
    ds_read_b64_tr_b16 v[66:67], v2 offset:0
    ds_read_b64_tr_b16 v[68:69], v2 offset:544
    ds_read_b64_tr_b16 v[70:71], v2 offset:32
    ds_read_b64_tr_b16 v[72:73], v2 offset:576
    ds_read_b64_tr_b16 v[74:75], v2 offset:64
    ds_read_b64_tr_b16 v[76:77], v2 offset:608
    ds_read_b64_tr_b16 v[78:79], v2 offset:96
    s_mov_b32 s85, 16777216
    s_waitcnt lgkmcnt(6)
    buffer_store_dwordx4 v[64:67], v3, s[12:15], s85 offen sc1
    s_mov_b32 s85, 16844800
    s_waitcnt lgkmcnt(4)
    buffer_store_dwordx4 v[68:71], v3, s[12:15], s85 offen sc1
    s_mov_b32 s85, 16912384
    s_waitcnt lgkmcnt(2)
    buffer_store_dwordx4 v[72:75], v3, s[12:15], s85 offen sc1
    s_mov_b32 s85, 16979968
    s_waitcnt lgkmcnt(0)
    buffer_store_dwordx4 v[76:79], v3, s[12:15], s85 offen sc1
    v_add_u32 v4, s83, v0
    v_mul_u32_u24 v4, 4224, v4
    v_mov_b32 v16, 0
    v_mov_b32 v17, 0
    v_mov_b32 v18, 0
    v_mov_b32 v19, 0
    s_cmp_eq_u32 s80, 0
    s_mov_b32 s84, 41943040
    s_cselect_b32 s85, 16781312, s84
    buffer_store_dwordx4 v[16:19], v4, s[12:15], s85 offen sc1
    v_mov_b32 v20, 0
    buffer_load_dword v21, v20, s[32:35], 0 offen sc1
    s_barrier
    s_barrier
    s_waitcnt vmcnt(0)
    v_readfirstlane_b32 s9, v21
    s_barrier
    s_cmp_lg_u32 s28, 0
    s_cbranch_scc1 L_nu_32
    s_lshr_b32 s84, s2, 4
    s_lshl_b32 s31, s81, 8
    s_lshl_b32 s95, s84, 2
    s_add_u32 s31, s31, s95
    s_add_u32 s31, s31, 31526912
    v_mov_b32 v8, 0
    v_mov_b32 v9, s9
    s_mov_b64 exec, 1
    buffer_store_dword v9, v8, s[12:15], s31 offen sc1
    s_mov_b64 exec, -1
L_nu_32:
    s_barrier
    s_barrier
    s_barrier
    s_barrier
    s_barrier
    s_barrier
    s_barrier
    s_barrier
    s_barrier
    v_mov_b32 v2, 160768
    v_mov_b32 v3, 0
    ds_write_b32 v2, v3
    s_lshl_b32 s94, s29, 8
    s_add_u32 s94, s94, 31531008
    v_and_b32 v8, 31, v0
    v_lshlrev_b32 v8, 2, v8
    s_mov_b32 s95, 0
L_poll_33:
    buffer_load_dword v9, v8, s[12:15], s94 offen sc1
    s_add_u32 s95, s95, 1
    s_waitcnt vmcnt(0)
    v_cmp_ne_u32 vcc, s9, v9
    s_cmp_eq_u64 vcc, 0
    s_cbranch_scc1 L_polld_34
    s_sleep 4
    s_cmp_lt_u32 s95, 0x400000
    s_cbranch_scc1 L_poll_33
L_polld_34:
    s_lshl_b32 s60, s29, 17
    s_lshl_b32 s61, s28, 11
    s_add_u32 s60, s60, s61
    s_lshl_b32 s62, s29, 6
    s_lshl_b32 s31, s30, 3
    s_add_u32 s62, s62, s31
    s_lshl_b32 s62, s62, 11
    s_lshl_b32 s63, s28, 12
    s_add_u32 s62, s62, s63
    s_add_u32 m0, s63, 49152
    s_add_u32 s31, s62, 0
    buffer_load_dwordx4 v1, s[12:15], s31 offen sc1 lds
    s_add_u32 m0, s63, 50176
    s_add_u32 s31, s62, 1024
    buffer_load_dwordx4 v1, s[12:15], s31 offen sc1 lds
    s_add_u32 m0, s63, 51200
    s_add_u32 s31, s62, 2048
    buffer_load_dwordx4 v1, s[12:15], s31 offen sc1 lds
    s_add_u32 m0, s63, 52224
    s_add_u32 s31, s62, 3072
    buffer_load_dwordx4 v1, s[12:15], s31 offen sc1 lds
    s_lshl_b32 s31, s29, 7
    s_add_u32 s31, s31, 31457280
    s_mov_b32 m0, 160832
    s_mov_b64 exec, 0xff
    buffer_load_dwordx4 v1, s[12:15], s31 offen sc1 lds
    s_mov_b64 exec, -1
    s_add_u32 m0, s61, 0
    s_add_u32 s31, s60, 4194304
    buffer_load_dwordx4 v1, s[12:15], s31 offen sc1 lds
    s_add_u32 m0, s61, 1024
    s_add_u32 s31, s60, 4195328
    buffer_load_dwordx4 v1, s[12:15], s31 offen sc1 lds
    s_add_u32 m0, s61, 8192
    s_add_u32 s31, s60, 8388608
    buffer_load_dwordx4 v1, s[12:15], s31 offen sc1 lds
    s_add_u32 m0, s61, 9216
    s_add_u32 s31, s60, 8389632
    buffer_load_dwordx4 v1, s[12:15], s31 offen sc1 lds
    s_add_u32 m0, s61, 16384
    s_add_u32 s31, s60, 4202496
    buffer_load_dwordx4 v1, s[12:15], s31 offen sc1 lds
    s_add_u32 m0, s61, 17408
    s_add_u32 s31, s60, 4203520
    buffer_load_dwordx4 v1, s[12:15], s31 offen sc1 lds
    s_add_u32 m0, s61, 24576
    s_add_u32 s31, s60, 8396800
    buffer_load_dwordx4 v1, s[12:15], s31 offen sc1 lds
    s_add_u32 m0, s61, 25600
    s_add_u32 s31, s60, 8397824
    buffer_load_dwordx4 v1, s[12:15], s31 offen sc1 lds
    s_waitcnt vmcnt(4)
    s_waitcnt lgkmcnt(0)
    s_barrier
    s_add_u32 m0, s61, 32768
    s_add_u32 s31, s60, 4210688
    buffer_load_dwordx4 v1, s[12:15], s31 offen sc1 lds
    s_add_u32 m0, s61, 33792
    s_add_u32 s31, s60, 4211712
    buffer_load_dwordx4 v1, s[12:15], s31 offen sc1 lds
    s_add_u32 m0, s61, 40960
    s_add_u32 s31, s60, 8404992
    buffer_load_dwordx4 v1, s[12:15], s31 offen sc1 lds
    s_add_u32 m0, s61, 41984
    s_add_u32 s31, s60, 8406016
    buffer_load_dwordx4 v1, s[12:15], s31 offen sc1 lds
    v_lshrrev_b32 v4, 3, v0
    v_and_b32 v5, 7, v0
    v_lshrrev_b32 v6, 1, v4
    v_and_b32 v6, 1, v6
    v_lshlrev_b32 v6, 2, v6
    v_xor_b32 v7, v5, v6
    v_lshlrev_b32 v7, 4, v7
    v_lshl_add_u32 v3, v4, 11, v7
    s_lshl_b32 s70, s4, 7
    s_lshl_b32 s71, s28, 14
    s_add_u32 s70, s70, s71
    s_lshl_b32 s71, s28, 10
    s_lshr_b32 s72, s2, 3
    s_and_b32 s73, s2, 7
    s_lshl_b32 s74, s73, 2
    s_add_u32 s74, s74, s28
    v_lshrrev_b32 v20, 4, v0
    v_and_b32 v10, 15, v0
    v_lshlrev_b32 v11, 11, v10
    v_lshl_add_u32 v11, v20, 4, v11
    v_lshlrev_b32 v12, 12, v10
    v_lshl_add_u32 v12, v20, 4, v12
    s_lshl_b32 s75, s72, 17
    s_lshl_b32 s76, s74, 6
    s_add_u32 s77, s75, s76
    s_lshl_b32 s75, s72, 18
    s_add_u32 s78, s75, s76
    v_lshrrev_b32 v13, 2, v10
    v_lshl_add_u32 v13, v20, 3, v13
    v_lshlrev_b32 v13, 7, v13
    v_and_b32 v14, 3, v10
    v_lshl_add_u32 v13, v14, 3, v13
    s_mul_i32 s79, s28, 3072
    s_add_u32 s79, s79, 161024
    s_lshl_b32 s79, s28, 12
    s_add_u32 s79, s79, 65536
    v_add_u32 v13, s79, v13
    v_add_u32 v15, s79, v1
    v_lshlrev_b32 v14, 12, v4
    v_lshl_add_u32 v14, v5, 4, v14
    s_lshl_b32 s75, s74, 17
    s_lshl_b32 s76, s72, 7
    s_add_u32 s75, s75, s76
    s_add_u32 s75, s75, 27262976
    s_waitcnt vmcnt(4)
    s_barrier
    s_add_u32 m0, s61, 49152
    s_add_u32 s31, s60, 4218880
    buffer_load_dwordx4 v1, s[12:15], s31 offen sc1 lds
    s_add_u32 m0, s61, 50176
    s_add_u32 s31, s60, 4219904
    buffer_load_dwordx4 v1, s[12:15], s31 offen sc1 lds
    s_add_u32 m0, s61, 57344
    s_add_u32 s31, s60, 8413184
    buffer_load_dwordx4 v1, s[12:15], s31 offen sc1 lds
    s_add_u32 m0, s61, 58368
    s_add_u32 s31, s60, 8414208
    buffer_load_dwordx4 v1, s[12:15], s31 offen sc1 lds
    s_cmp_lg_u32 s28, 0
    s_cbranch_scc1 L_ny_35
    s_lshr_b32 s84, s2, 5
    s_and_b32 s85, s2, 31
    s_lshl_b32 s31, s84, 8
    s_lshl_b32 s95, s85, 2
    s_add_u32 s31, s31, s95
    s_add_u32 s31, s31, 31524864
    v_mov_b32 v8, 0
    v_mov_b32 v9, s9
    s_mov_b64 exec, 1
    buffer_store_dword v9, v8, s[12:15], s31 offen sc1
    s_mov_b64 exec, -1
L_ny_35:
    s_waitcnt vmcnt(4)
    s_barrier
    s_add_u32 m0, s61, 0
    s_add_u32 s31, s60, 4227072
    buffer_load_dwordx4 v1, s[12:15], s31 offen sc1 lds
    s_add_u32 m0, s61, 1024
    s_add_u32 s31, s60, 4228096
    buffer_load_dwordx4 v1, s[12:15], s31 offen sc1 lds
    s_add_u32 m0, s61, 8192
    s_add_u32 s31, s60, 8421376
    buffer_load_dwordx4 v1, s[12:15], s31 offen sc1 lds
    s_add_u32 m0, s61, 9216
    s_add_u32 s31, s60, 8422400
    buffer_load_dwordx4 v1, s[12:15], s31 offen sc1 lds
    s_waitcnt vmcnt(4)
    s_barrier
    s_add_u32 m0, s61, 16384
    s_add_u32 s31, s60, 4235264
    buffer_load_dwordx4 v1, s[12:15], s31 offen sc1 lds
    s_add_u32 m0, s61, 17408
    s_add_u32 s31, s60, 4236288
    buffer_load_dwordx4 v1, s[12:15], s31 offen sc1 lds
    s_add_u32 m0, s61, 24576
    s_add_u32 s31, s60, 8429568
    buffer_load_dwordx4 v1, s[12:15], s31 offen sc1 lds
    s_add_u32 m0, s61, 25600
    s_add_u32 s31, s60, 8430592
    buffer_load_dwordx4 v1, s[12:15], s31 offen sc1 lds
    s_waitcnt vmcnt(4)
    s_barrier
    s_add_u32 m0, s61, 32768
    s_add_u32 s31, s60, 4243456
    buffer_load_dwordx4 v1, s[12:15], s31 offen sc1 lds
    s_add_u32 m0, s61, 33792
    s_add_u32 s31, s60, 4244480
    buffer_load_dwordx4 v1, s[12:15], s31 offen sc1 lds
    s_add_u32 m0, s61, 40960
    s_add_u32 s31, s60, 8437760
    buffer_load_dwordx4 v1, s[12:15], s31 offen sc1 lds
    s_add_u32 m0, s61, 41984
    s_add_u32 s31, s60, 8438784
    buffer_load_dwordx4 v1, s[12:15], s31 offen sc1 lds
    s_add_u32 s31, s77, 0
    buffer_load_dwordx4 v[32:35], v11, s[24:27], s31 offen
    s_add_u32 s31, s77, 32768
    buffer_load_dwordx4 v[36:39], v11, s[24:27], s31 offen
    s_add_u32 s31, s77, 65536
    buffer_load_dwordx4 v[40:43], v11, s[24:27], s31 offen
    s_add_u32 s31, s77, 98304
    buffer_load_dwordx4 v[44:47], v11, s[24:27], s31 offen
    s_waitcnt vmcnt(8)
    s_barrier
    s_add_u32 m0, s61, 49152
    s_add_u32 s31, s60, 4251648
    buffer_load_dwordx4 v1, s[12:15], s31 offen sc1 lds
    s_add_u32 m0, s61, 50176
    s_add_u32 s31, s60, 4252672
    buffer_load_dwordx4 v1, s[12:15], s31 offen sc1 lds
    s_add_u32 m0, s61, 57344
    s_add_u32 s31, s60, 8445952
    buffer_load_dwordx4 v1, s[12:15], s31 offen sc1 lds
    s_add_u32 m0, s61, 58368
    s_add_u32 s31, s60, 8446976
    buffer_load_dwordx4 v1, s[12:15], s31 offen sc1 lds
    s_waitcnt vmcnt(8)
    s_barrier
    s_add_u32 m0, s61, 0
    s_add_u32 s31, s60, 4259840
    buffer_load_dwordx4 v1, s[12:15], s31 offen sc1 lds
    s_add_u32 m0, s61, 1024
    s_add_u32 s31, s60, 4260864
    buffer_load_dwordx4 v1, s[12:15], s31 offen sc1 lds
    s_add_u32 m0, s61, 8192
    s_add_u32 s31, s60, 8454144
    buffer_load_dwordx4 v1, s[12:15], s31 offen sc1 lds
    s_add_u32 m0, s61, 9216
    s_add_u32 s31, s60, 8455168
    buffer_load_dwordx4 v1, s[12:15], s31 offen sc1 lds
    s_lshl_b32 s94, s73, 8
    s_add_u32 s94, s94, 31524864
    v_and_b32 v8, 31, v0
    v_lshlrev_b32 v8, 2, v8
    s_mov_b32 s95, 0
L_poll_36:
    buffer_load_dword v9, v8, s[12:15], s94 offen sc1
    s_add_u32 s95, s95, 1
    s_waitcnt vmcnt(0)
    v_cmp_ne_u32 vcc, s9, v9
    s_cmp_eq_u64 vcc, 0
    s_cbranch_scc1 L_polld_37
    s_sleep 4
    s_cmp_lt_u32 s95, 0x400000
    s_cbranch_scc1 L_poll_36
L_polld_37:
    s_add_u32 s31, s75, 0
    buffer_load_dwordx4 v[64:67], v14, s[12:15], s31 offen sc1
    s_add_u32 s31, s75, 32768
    buffer_load_dwordx4 v[68:71], v14, s[12:15], s31 offen sc1
    s_add_u32 s31, s75, 65536
    buffer_load_dwordx4 v[72:75], v14, s[12:15], s31 offen sc1
    s_add_u32 s31, s75, 98304
    buffer_load_dwordx4 v[76:79], v14, s[12:15], s31 offen sc1
    s_waitcnt vmcnt(8)
    s_barrier
    s_add_u32 m0, s61, 16384
    s_add_u32 s31, s60, 4268032
    buffer_load_dwordx4 v1, s[12:15], s31 offen sc1 lds
    s_add_u32 m0, s61, 17408
    s_add_u32 s31, s60, 4269056
    buffer_load_dwordx4 v1, s[12:15], s31 offen sc1 lds
    s_add_u32 m0, s61, 24576
    s_add_u32 s31, s60, 8462336
    buffer_load_dwordx4 v1, s[12:15], s31 offen sc1 lds
    s_add_u32 m0, s61, 25600
    s_add_u32 s31, s60, 8463360
    buffer_load_dwordx4 v1, s[12:15], s31 offen sc1 lds
    s_waitcnt vmcnt(8)
    s_barrier
    s_add_u32 m0, s61, 32768
    s_add_u32 s31, s60, 4276224
    buffer_load_dwordx4 v1, s[12:15], s31 offen sc1 lds
    s_add_u32 m0, s61, 33792
    s_add_u32 s31, s60, 4277248
    buffer_load_dwordx4 v1, s[12:15], s31 offen sc1 lds
    s_add_u32 m0, s61, 40960
    s_add_u32 s31, s60, 8470528
    buffer_load_dwordx4 v1, s[12:15], s31 offen sc1 lds
    s_add_u32 m0, s61, 41984
    s_add_u32 s31, s60, 8471552
    buffer_load_dwordx4 v1, s[12:15], s31 offen sc1 lds
    s_waitcnt vmcnt(8)
    ds_write_b128 v15, v[64:67] offset:0
    ds_write_b128 v15, v[68:71] offset:1024
    ds_write_b128 v15, v[72:75] offset:2048
    ds_write_b128 v15, v[76:79] offset:3072
    s_waitcnt lgkmcnt(0)
    ds_read_b64_tr_b16 v[48:49], v13 offset:0
    ds_read_b64_tr_b16 v[50:51], v13 offset:512
    ds_read_b64_tr_b16 v[52:53], v13 offset:32
    ds_read_b64_tr_b16 v[54:55], v13 offset:544
    ds_read_b64_tr_b16 v[56:57], v13 offset:64
    ds_read_b64_tr_b16 v[58:59], v13 offset:576
    ds_read_b64_tr_b16 v[60:61], v13 offset:96
    ds_read_b64_tr_b16 v[62:63], v13 offset:608
    s_waitcnt lgkmcnt(6)
    v_lshlrev_b32 v16, 16, v32
    v_and_b32 v17, 0xffff0000, v32
    v_lshlrev_b32 v18, 16, v48
    v_and_b32 v19, 0xffff0000, v48
    v_mul_f32 v16, v16, v18
    v_mul_f32 v17, v17, v19
    v_cvt_pk_bf16_f32 v80, v16, v17
    v_lshlrev_b32 v16, 16, v33
    v_and_b32 v17, 0xffff0000, v33
    v_lshlrev_b32 v18, 16, v49
    v_and_b32 v19, 0xffff0000, v49
    v_mul_f32 v16, v16, v18
    v_mul_f32 v17, v17, v19
    v_cvt_pk_bf16_f32 v81, v16, v17
    v_lshlrev_b32 v16, 16, v34
    v_and_b32 v17, 0xffff0000, v34
    v_lshlrev_b32 v18, 16, v50
    v_and_b32 v19, 0xffff0000, v50
    v_mul_f32 v16, v16, v18
    v_mul_f32 v17, v17, v19
    v_cvt_pk_bf16_f32 v82, v16, v17
    v_lshlrev_b32 v16, 16, v35
    v_and_b32 v17, 0xffff0000, v35
    v_lshlrev_b32 v18, 16, v51
    v_and_b32 v19, 0xffff0000, v51
    v_mul_f32 v16, v16, v18
    v_mul_f32 v17, v17, v19
    v_cvt_pk_bf16_f32 v83, v16, v17
    s_add_u32 s31, s78, 0
    buffer_store_dwordx4 v[80:83], v12, s[36:39], s31 offen
    s_waitcnt lgkmcnt(4)
    v_lshlrev_b32 v16, 16, v36
    v_and_b32 v17, 0xffff0000, v36
    v_lshlrev_b32 v18, 16, v52
    v_and_b32 v19, 0xffff0000, v52
    v_mul_f32 v16, v16, v18
    v_mul_f32 v17, v17, v19
    v_cvt_pk_bf16_f32 v84, v16, v17
    v_lshlrev_b32 v16, 16, v37
    v_and_b32 v17, 0xffff0000, v37
    v_lshlrev_b32 v18, 16, v53
    v_and_b32 v19, 0xffff0000, v53
    v_mul_f32 v16, v16, v18
    v_mul_f32 v17, v17, v19
    v_cvt_pk_bf16_f32 v85, v16, v17
    v_lshlrev_b32 v16, 16, v38
    v_and_b32 v17, 0xffff0000, v38
    v_lshlrev_b32 v18, 16, v54
    v_and_b32 v19, 0xffff0000, v54
    v_mul_f32 v16, v16, v18
    v_mul_f32 v17, v17, v19
    v_cvt_pk_bf16_f32 v86, v16, v17
    v_lshlrev_b32 v16, 16, v39
    v_and_b32 v17, 0xffff0000, v39
    v_lshlrev_b32 v18, 16, v55
    v_and_b32 v19, 0xffff0000, v55
    v_mul_f32 v16, v16, v18
    v_mul_f32 v17, v17, v19
    v_cvt_pk_bf16_f32 v87, v16, v17
    s_add_u32 s31, s78, 65536
    buffer_store_dwordx4 v[84:87], v12, s[36:39], s31 offen
    s_waitcnt lgkmcnt(2)
    v_lshlrev_b32 v16, 16, v40
    v_and_b32 v17, 0xffff0000, v40
    v_lshlrev_b32 v18, 16, v56
    v_and_b32 v19, 0xffff0000, v56
    v_mul_f32 v16, v16, v18
    v_mul_f32 v17, v17, v19
    v_cvt_pk_bf16_f32 v88, v16, v17
    v_lshlrev_b32 v16, 16, v41
    v_and_b32 v17, 0xffff0000, v41
    v_lshlrev_b32 v18, 16, v57
    v_and_b32 v19, 0xffff0000, v57
    v_mul_f32 v16, v16, v18
    v_mul_f32 v17, v17, v19
    v_cvt_pk_bf16_f32 v89, v16, v17
    v_lshlrev_b32 v16, 16, v42
    v_and_b32 v17, 0xffff0000, v42
    v_lshlrev_b32 v18, 16, v58
    v_and_b32 v19, 0xffff0000, v58
    v_mul_f32 v16, v16, v18
    v_mul_f32 v17, v17, v19
    v_cvt_pk_bf16_f32 v90, v16, v17
    v_lshlrev_b32 v16, 16, v43
    v_and_b32 v17, 0xffff0000, v43
    v_lshlrev_b32 v18, 16, v59
    v_and_b32 v19, 0xffff0000, v59
    v_mul_f32 v16, v16, v18
    v_mul_f32 v17, v17, v19
    v_cvt_pk_bf16_f32 v91, v16, v17
    s_add_u32 s31, s78, 131072
    buffer_store_dwordx4 v[88:91], v12, s[36:39], s31 offen
    s_waitcnt lgkmcnt(0)
    v_lshlrev_b32 v16, 16, v44
    v_and_b32 v17, 0xffff0000, v44
    v_lshlrev_b32 v18, 16, v60
    v_and_b32 v19, 0xffff0000, v60
    v_mul_f32 v16, v16, v18
    v_mul_f32 v17, v17, v19
    v_cvt_pk_bf16_f32 v92, v16, v17
    v_lshlrev_b32 v16, 16, v45
    v_and_b32 v17, 0xffff0000, v45
    v_lshlrev_b32 v18, 16, v61
    v_and_b32 v19, 0xffff0000, v61
    v_mul_f32 v16, v16, v18
    v_mul_f32 v17, v17, v19
    v_cvt_pk_bf16_f32 v93, v16, v17
    v_lshlrev_b32 v16, 16, v46
    v_and_b32 v17, 0xffff0000, v46
    v_lshlrev_b32 v18, 16, v62
    v_and_b32 v19, 0xffff0000, v62
    v_mul_f32 v16, v16, v18
    v_mul_f32 v17, v17, v19
    v_cvt_pk_bf16_f32 v94, v16, v17
    v_lshlrev_b32 v16, 16, v47
    v_and_b32 v17, 0xffff0000, v47
    v_lshlrev_b32 v18, 16, v63
    v_and_b32 v19, 0xffff0000, v63
    v_mul_f32 v16, v16, v18
    v_mul_f32 v17, v17, v19
    v_cvt_pk_bf16_f32 v95, v16, v17
    s_add_u32 s31, s78, 196608
    buffer_store_dwordx4 v[92:95], v12, s[36:39], s31 offen
    s_waitcnt vmcnt(8)
    s_barrier
    s_add_u32 m0, s61, 49152
    s_add_u32 s31, s60, 4284416
    buffer_load_dwordx4 v1, s[12:15], s31 offen sc1 lds
    s_add_u32 m0, s61, 50176
    s_add_u32 s31, s60, 4285440
    buffer_load_dwordx4 v1, s[12:15], s31 offen sc1 lds
    s_add_u32 m0, s61, 57344
    s_add_u32 s31, s60, 8478720
    buffer_load_dwordx4 v1, s[12:15], s31 offen sc1 lds
    s_add_u32 m0, s61, 58368
    s_add_u32 s31, s60, 8479744
    buffer_load_dwordx4 v1, s[12:15], s31 offen sc1 lds
    s_waitcnt vmcnt(8)
    s_barrier
    s_add_u32 m0, s61, 0
    s_add_u32 s31, s60, 4292608
    buffer_load_dwordx4 v1, s[12:15], s31 offen sc1 lds
    s_add_u32 m0, s61, 1024
    s_add_u32 s31, s60, 4293632
    buffer_load_dwordx4 v1, s[12:15], s31 offen sc1 lds
    s_add_u32 m0, s61, 8192
    s_add_u32 s31, s60, 8486912
    buffer_load_dwordx4 v1, s[12:15], s31 offen sc1 lds
    s_add_u32 m0, s61, 9216
    s_add_u32 s31, s60, 8487936
    buffer_load_dwordx4 v1, s[12:15], s31 offen sc1 lds
    s_add_u32 m0, s71, 65536
    s_add_u32 s31, s70, 0
    buffer_load_dwordx4 v3, s[20:23], s31 offen lds
    s_add_u32 m0, s71, 69632
    s_add_u32 s31, s70, 65536
    buffer_load_dwordx4 v3, s[20:23], s31 offen lds
    s_add_u32 m0, s71, 73728
    s_add_u32 s31, s70, 131072
    buffer_load_dwordx4 v3, s[20:23], s31 offen lds
    s_add_u32 m0, s71, 77824
    s_add_u32 s31, s70, 196608
    buffer_load_dwordx4 v3, s[20:23], s31 offen lds
    s_waitcnt vmcnt(8)
    s_barrier
    s_add_u32 m0, s61, 16384
    s_add_u32 s31, s60, 4300800
    buffer_load_dwordx4 v1, s[12:15], s31 offen sc1 lds
    s_add_u32 m0, s61, 17408
    s_add_u32 s31, s60, 4301824
    buffer_load_dwordx4 v1, s[12:15], s31 offen sc1 lds
    s_add_u32 m0, s61, 24576
    s_add_u32 s31, s60, 8495104
    buffer_load_dwordx4 v1, s[12:15], s31 offen sc1 lds
    s_add_u32 m0, s61, 25600
    s_add_u32 s31, s60, 8496128
    buffer_load_dwordx4 v1, s[12:15], s31 offen sc1 lds
    s_add_u32 m0, s71, 81920
    s_add_u32 s31, s70, 262144
    buffer_load_dwordx4 v3, s[20:23], s31 offen lds
    s_add_u32 m0, s71, 86016
    s_add_u32 s31, s70, 327680
    buffer_load_dwordx4 v3, s[20:23], s31 offen lds
    s_add_u32 m0, s71, 90112
    s_add_u32 s31, s70, 393216
    buffer_load_dwordx4 v3, s[20:23], s31 offen lds
    s_add_u32 m0, s71, 94208
    s_add_u32 s31, s70, 458752
    buffer_load_dwordx4 v3, s[20:23], s31 offen lds
    s_waitcnt vmcnt(12)
    s_barrier
    s_add_u32 m0, s61, 32768
    s_add_u32 s31, s60, 4308992
    buffer_load_dwordx4 v1, s[12:15], s31 offen sc1 lds
    s_add_u32 m0, s61, 33792
    s_add_u32 s31, s60, 4310016
    buffer_load_dwordx4 v1, s[12:15], s31 offen sc1 lds
    s_add_u32 m0, s61, 40960
    s_add_u32 s31, s60, 8503296
    buffer_load_dwordx4 v1, s[12:15], s31 offen sc1 lds
    s_add_u32 m0, s61, 41984
    s_add_u32 s31, s60, 8504320
    buffer_load_dwordx4 v1, s[12:15], s31 offen sc1 lds
    s_add_u32 m0, s71, 98304
    s_add_u32 s31, s70, 524288
    buffer_load_dwordx4 v3, s[20:23], s31 offen lds
    s_add_u32 m0, s71, 102400
    s_add_u32 s31, s70, 589824
    buffer_load_dwordx4 v3, s[20:23], s31 offen lds
    s_add_u32 m0, s71, 106496
    s_add_u32 s31, s70, 655360
    buffer_load_dwordx4 v3, s[20:23], s31 offen lds
    s_add_u32 m0, s71, 110592
    s_add_u32 s31, s70, 720896
    buffer_load_dwordx4 v3, s[20:23], s31 offen lds
    s_waitcnt vmcnt(12)
    s_barrier
    s_add_u32 m0, s61, 49152
    s_add_u32 s31, s60, 4317184
    buffer_load_dwordx4 v1, s[12:15], s31 offen sc1 lds
    s_add_u32 m0, s61, 50176
    s_add_u32 s31, s60, 4318208
    buffer_load_dwordx4 v1, s[12:15], s31 offen sc1 lds
    s_add_u32 m0, s61, 57344
    s_add_u32 s31, s60, 8511488
    buffer_load_dwordx4 v1, s[12:15], s31 offen sc1 lds
    s_add_u32 m0, s61, 58368
    s_add_u32 s31, s60, 8512512
    buffer_load_dwordx4 v1, s[12:15], s31 offen sc1 lds
    s_add_u32 m0, s71, 114688
    s_add_u32 s31, s70, 786432
    buffer_load_dwordx4 v3, s[20:23], s31 offen lds
    s_add_u32 m0, s71, 118784
    s_add_u32 s31, s70, 851968
    buffer_load_dwordx4 v3, s[20:23], s31 offen lds
    s_add_u32 m0, s71, 122880
    s_add_u32 s31, s70, 917504
    buffer_load_dwordx4 v3, s[20:23], s31 offen lds
    s_add_u32 m0, s71, 126976
    s_add_u32 s31, s70, 983040
    buffer_load_dwordx4 v3, s[20:23], s31 offen lds
    s_waitcnt vmcnt(12)
    s_barrier
    s_add_u32 m0, s71, 131072
    s_add_u32 s31, s70, 1048576
    buffer_load_dwordx4 v3, s[20:23], s31 offen lds
    s_add_u32 m0, s71, 135168
    s_add_u32 s31, s70, 1114112
    buffer_load_dwordx4 v3, s[20:23], s31 offen lds
    s_add_u32 m0, s71, 139264
    s_add_u32 s31, s70, 1179648
    buffer_load_dwordx4 v3, s[20:23], s31 offen lds
    s_add_u32 m0, s71, 143360
    s_add_u32 s31, s70, 1245184
    buffer_load_dwordx4 v3, s[20:23], s31 offen lds
    s_waitcnt vmcnt(8)
    s_barrier
    s_barrier
    s_barrier
    v_mov_b32 v6, 160768
    ds_read_b32 v7, v6
    s_waitcnt lgkmcnt(0)
    v_readfirstlane_b32 s31, v7
    s_nop 3
    s_cmp_eq_u32 s31, 0
    s_cbranch_scc1 L_hd_38
    s_mov_b32 s8, 0
    s_and_b32 s84, s8, 3
    s_lshl_b32 s84, s84, 14
    s_add_u32 s84, s84, s61
    s_lshl_b32 s85, s8, 13
    s_add_u32 s85, s85, s60
    s_add_u32 m0, s84, 0
    s_add_u32 s31, s85, 4194304
    buffer_load_dwordx4 v1, s[12:15], s31 offen sc1 lds
    s_add_u32 m0, s84, 1024
    s_add_u32 s31, s85, 4195328
    buffer_load_dwordx4 v1, s[12:15], s31 offen sc1 lds
    s_add_u32 m0, s84, 8192
    s_add_u32 s31, s85, 8388608
    buffer_load_dwordx4 v1, s[12:15], s31 offen sc1 lds
    s_add_u32 m0, s84, 9216
    s_add_u32 s31, s85, 8389632
    buffer_load_dwordx4 v1, s[12:15], s31 offen sc1 lds
    s_add_u32 s8, s8, 1
    s_waitcnt vmcnt(0)
    s_barrier
L_p2_39:
    s_and_b32 s84, s8, 3
    s_lshl_b32 s84, s84, 14
    s_add_u32 s84, s84, s61
    s_lshl_b32 s85, s8, 13
    s_add_u32 s85, s85, s60
    s_add_u32 m0, s84, 0
    s_add_u32 s31, s85, 4194304
    buffer_load_dwordx4 v1, s[12:15], s31 offen sc1 lds
    s_add_u32 m0, s84, 1024
    s_add_u32 s31, s85, 4195328
    buffer_load_dwordx4 v1, s[12:15], s31 offen sc1 lds
    s_add_u32 m0, s84, 8192
    s_add_u32 s31, s85, 8388608
    buffer_load_dwordx4 v1, s[12:15], s31 offen sc1 lds
    s_add_u32 m0, s84, 9216
    s_add_u32 s31, s85, 8389632
    buffer_load_dwordx4 v1, s[12:15], s31 offen sc1 lds
    s_add_u32 s8, s8, 1
    s_waitcnt vmcnt(0)
    s_barrier
    s_cmp_lt_u32 s8, 16
    s_cbranch_scc1 L_p2_39
    s_barrier
L_hd_38:
    s_barrier
    s_add_u32 m0, s71, 0
    s_add_u32 s31, s70, 1310720
    buffer_load_dwordx4 v3, s[20:23], s31 offen lds
    s_add_u32 m0, s71, 4096
    s_add_u32 s31, s70, 1376256
    buffer_load_dwordx4 v3, s[20:23], s31 offen lds
    s_add_u32 m0, s71, 8192
    s_add_u32 s31, s70, 1441792
    buffer_load_dwordx4 v3, s[20:23], s31 offen lds
    s_add_u32 m0, s71, 12288
    s_add_u32 s31, s70, 1507328
    buffer_load_dwordx4 v3, s[20:23], s31 offen lds
    s_add_u32 m0, s71, 16384
    s_add_u32 s31, s70, 1572864
    buffer_load_dwordx4 v3, s[20:23], s31 offen lds
    s_add_u32 m0, s71, 20480
    s_add_u32 s31, s70, 1638400
    buffer_load_dwordx4 v3, s[20:23], s31 offen lds
    s_add_u32 m0, s71, 24576
    s_add_u32 s31, s70, 1703936
    buffer_load_dwordx4 v3, s[20:23], s31 offen lds
    s_add_u32 m0, s71, 28672
    s_add_u32 s31, s70, 1769472
    buffer_load_dwordx4 v3, s[20:23], s31 offen lds
    s_add_u32 m0, s71, 32768
    s_add_u32 s31, s70, 1835008
    buffer_load_dwordx4 v3, s[20:23], s31 offen lds
    s_add_u32 m0, s71, 36864
    s_add_u32 s31, s70, 1900544
    buffer_load_dwordx4 v3, s[20:23], s31 offen lds
    s_add_u32 m0, s71, 40960
    s_add_u32 s31, s70, 1966080
    buffer_load_dwordx4 v3, s[20:23], s31 offen lds
    s_add_u32 m0, s71, 45056
    s_add_u32 s31, s70, 2031616
    buffer_load_dwordx4 v3, s[20:23], s31 offen lds
    s_waitcnt vmcnt(0)
    s_endpgm
L_kfend_1:
    s_endpgm
.section .rodata,"a"
.p2align 6
.amdhsa_kernel kf_kernel
  .amdhsa_next_free_vgpr 160
  .amdhsa_next_free_sgpr 102
  .amdhsa_accum_offset 160
  .amdhsa_group_segment_fixed_size 0
  .amdhsa_kernarg_size 96
  .amdhsa_user_sgpr_count 2
  .amdhsa_user_sgpr_kernarg_segment_ptr 1
  .amdhsa_system_sgpr_workgroup_id_x 1
.end_amdhsa_kernel
```
